```python
import torch

def _softmax(x, axis=-1):
    return torch.softmax(x, dim=axis)
def _gelu(x):
    return torch.nn.functional.gelu(x, approximate="tanh")
def _silu(x):
    return torch.nn.functional.silu(x)
def _sigmoid(x):
    return torch.sigmoid(x)
def _layernorm(x, axis=-1, eps=1e-5):
    m = x.mean(dim=axis, keepdim=True)
    v = x.var(dim=axis, keepdim=True, unbiased=False)
    return (x - m) / torch.sqrt(v + eps)
def _scatter_add(tgt, idx, src, axis=0):
    return tgt.clone().index_add_(axis, idx, src)
def _segment_sum(src, seg, n):
    out = torch.zeros((n,) + src.shape[1:], dtype=src.dtype)
    return out.index_add_(0, seg, src)
def _pad(x, pw):
    flat = tuple(v for pair in reversed(pw) for v in pair)
    return torch.nn.functional.pad(x, flat)

kernel_name = 'sequential_preLN__mha_block_cached__glu_gated_glu__decode'

def setup_inputs():

    _w = (lambda a: (lambda t: t.to(torch.bfloat16) if t.is_floating_point() else t)(torch.as_tensor(a)))
    def _A_setup():
        B, Sq, D = 1, 1, 512
        H, Sk, Dh = 32, 4096, 128
        return {
            "x": _w((lambda *s: torch.randn(*s, dtype=torch.bfloat16) * 0.1)(B, Sq, D)),
            "k_cache": _w((lambda *s: torch.randn(*s, dtype=torch.bfloat16) * 0.8)(B, H, Sk, Dh)),
            "v_cache": _w((lambda *s: torch.randn(*s, dtype=torch.bfloat16) * 1.6)(B, H, Sk, Dh)),
            "wq": _w((lambda *s: torch.randn(*s, dtype=torch.bfloat16) * 0.8)(D, H * Dh) * (D ** -0.5)),
            "wo": _w((lambda *s: torch.randn(*s, dtype=torch.bfloat16) * 1.6)(H * Dh, D) * ((H * Dh) ** -0.5)),
        }
    _A_in = _A_setup()

    def _B_setup():
        B, S, D, F = 1, 1, 512, 1376
        return {
            "x": _w((lambda *s: torch.randn(*s, dtype=torch.bfloat16) * 0.1)(B, S, D)),
            "w_gate": _w((lambda *s: torch.randn(*s, dtype=torch.bfloat16) * 3.2)(D, F)),
            "w_up": _w((lambda *s: torch.randn(*s, dtype=torch.bfloat16) * 0.2)(D, F)),
            "w_down": _w((lambda *s: torch.randn(*s, dtype=torch.bfloat16) * 0.2)(F, D)),
        }
    _B_in = _B_setup()

    return {
        "A_x": _A_in["x"],
        "A_k_cache": _A_in["k_cache"],
        "A_v_cache": _A_in["v_cache"],
        "A_wq": _A_in["wq"],
        "A_wo": _A_in["wo"],
        "B_x": _B_in["x"],
        "B_w_gate": _B_in["w_gate"],
        "B_w_up": _B_in["w_up"],
        "B_w_down": _B_in["w_down"],
    }

def reference(A_x, A_k_cache, A_v_cache, A_wq, A_wo, B_x, B_w_gate, B_w_up, B_w_down):
    def _A_ref(x, k_cache, v_cache, wq, wo):
        B, Sq, D = x.shape
        H, Dh = 32, 128
        q = (lambda x, *d: x.permute(*d))((x @ wq).reshape(B, Sq, H, Dh), 0, 2, 1, 3)
        scores = torch.einsum("bhqd,bhkd->bhqk", q, k_cache) * (Dh ** -0.5)
        p = _softmax(scores, axis=-1)
        o = torch.einsum("bhqk,bhkd->bhqd", p, v_cache)
        return (lambda x, *d: x.permute(*d))(o, 0, 2, 1, 3).reshape(B, Sq, H * Dh) @ wo

    def _B_ref(x, w_gate, w_up, w_down):
        g = torch.einsum("bsd,df->bsf", x, w_gate)
        u = torch.einsum("bsd,df->bsf", x, w_up)
        h = _sigmoid(g) * u
        return torch.einsum("bsf,fd->bsd", h, w_down)

    x = A_x
    h = x + _A_ref(_layernorm(x, axis=-1), A_k_cache, A_v_cache, A_wq, A_wo)
    h2 = h + _B_ref(_layernorm(h, axis=-1), B_w_gate, B_w_up, B_w_down)
    return h2
```

```asm
; @launch grid=(256,1,1) block=(512,1,1) lds=57344
.amdgcn_target "amdgcn-amd-amdhsa--gfx950"
.text
.globl sequential_preLN__mha_block_cached__glu_gated_glu__decode_kernel
.p2align 8
.type sequential_preLN__mha_block_cached__glu_gated_glu__decode_kernel,@function
sequential_preLN__mha_block_cached__glu_gated_glu__decode_kernel:
    s_cmp_ge_u32 s2, 256
    s_cbranch_scc1 L_end
    s_load_dwordx2 s[4:5], s[0:1], 8
    s_load_dwordx16 s[64:79], s[0:1], 0
    s_load_dwordx8 s[80:87], s[0:1], 64
    v_lshrrev_b32 v1, 6, v0
    v_and_b32 v0, 63, v0
    v_readfirstlane_b32 s3, v1
    v_lshlrev_b32 v2, 4, v0
    s_cmp_lg_u32 s3, 7
    s_cbranch_scc1 L_nocpre
    s_getpc_b64 s[60:61]
L_pc:
    v_lshlrev_b32 v6, 7, v0
    s_sub_u32 s60, s60, L_pc-sequential_preLN__mha_block_cached__glu_gated_glu__decode_kernel
    s_subb_u32 s61, s61, 0
    v_add_u32 v5, 4096, v6
    global_load_dword v30, v6, s[60:61]
    s_mov_b32 exec_lo, 0
    global_load_dword v30, v5, s[60:61]
    s_mov_b64 exec, -1
L_nocpre:
    s_and_b32 s48, s2, 7
    s_lshr_b32 s49, s2, 3
    s_lshl_b32 s52, s48, 5
    s_add_u32 s52, s52, s49
    s_and_b32 s53, s3, 3
    s_lshl_b32 s54, s52, 7
    s_add_u32 s54, s54, s53
    s_lshl_b32 s54, s54, 10
    s_mov_b32 s6, 0x2000000
    s_mov_b32 s7, 0x20000
    s_lshr_b32 s50, s52, 3
    s_and_b32 s51, s52, 7
    s_cmp_ge_u32 s3, 4
    s_cbranch_scc1 L_vwave
    s_waitcnt lgkmcnt(0)
    buffer_load_dwordx4 v[128:131], v2, s[4:7], s54 offen nt
    s_add_u32 s54, s54, 4096
    buffer_load_dwordx4 v[132:135], v2, s[4:7], s54 offen nt
    s_add_u32 s54, s54, 4096
    s_barrier
    buffer_load_dwordx4 v[136:139], v2, s[4:7], s54 offen nt
    s_add_u32 s54, s54, 4096
    buffer_load_dwordx4 v[140:143], v2, s[4:7], s54 offen nt
    s_add_u32 s54, s54, 4096
    buffer_load_dwordx4 v[144:147], v2, s[4:7], s54 offen nt
    s_add_u32 s54, s54, 4096
    buffer_load_dwordx4 v[148:151], v2, s[4:7], s54 offen nt
    s_add_u32 s54, s54, 4096
    buffer_load_dwordx4 v[152:155], v2, s[4:7], s54 offen nt
    s_add_u32 s54, s54, 4096
    buffer_load_dwordx4 v[156:159], v2, s[4:7], s54 offen nt
    s_add_u32 s54, s54, 4096
    buffer_load_dwordx4 v[160:163], v2, s[4:7], s54 offen nt
    s_add_u32 s54, s54, 4096
    s_mov_b64 s[16:17], s[64:65]
    s_mov_b32 s18, 1024
    s_mov_b32 s19, 0x20000
    s_mov_b64 s[44:45], s[86:87]
    s_mov_b32 s46, 268435456
    s_mov_b32 s47, 0x20000
    s_mov_b64 s[40:41], s[84:85]
    s_mov_b32 s42, 256
    s_mov_b32 s43, 0x20000
    s_mov_b64 s[20:21], s[72:73]
    s_mov_b32 s22, 4194304
    s_mov_b32 s23, 0x20000
    s_mov_b64 s[24:25], s[76:77]
    s_mov_b32 s26, 1409024
    s_mov_b32 s27, 0x20000
    s_mov_b64 s[28:29], s[78:79]
    s_mov_b32 s30, 1409024
    s_mov_b32 s31, 0x20000
    s_mov_b64 s[32:33], s[80:81]
    s_mov_b32 s34, 1409024
    s_mov_b32 s35, 0x20000
    s_mov_b64 s[36:37], s[82:83]
    s_mov_b32 s38, 1024
    s_mov_b32 s39, 0x20000
    v_lshrrev_b32 v3, 4, v0
    v_and_b32 v4, 15, v0
    v_mov_b32 v24, 0
    v_mov_b32 v25, 1
    v_lshlrev_b32 v26, 3, v0
    v_lshlrev_b32 v27, 2, v0
    s_load_dword s97, s[44:45], 294912
    buffer_load_dwordx4 v[164:167], v2, s[4:7], s54 offen nt
    s_add_u32 s54, s54, 4096
    s_waitcnt vmcnt(9)
    buffer_load_dwordx4 v[168:171], v2, s[4:7], s54 offen nt
    s_add_u32 s54, s54, 4096
    s_waitcnt vmcnt(9)
    buffer_load_dwordx4 v[172:175], v2, s[4:7], s54 offen nt
    s_add_u32 s54, s54, 4096
    s_waitcnt vmcnt(9)
    buffer_load_dwordx4 v[176:179], v2, s[4:7], s54 offen nt
    s_add_u32 s54, s54, 4096
    s_waitcnt vmcnt(9)
    buffer_load_dwordx4 v[180:183], v2, s[4:7], s54 offen nt
    s_add_u32 s54, s54, 4096
    s_waitcnt vmcnt(9)
    buffer_load_dwordx4 v[184:187], v2, s[4:7], s54 offen nt
    s_add_u32 s54, s54, 4096
    s_waitcnt vmcnt(9)
    buffer_load_dwordx4 v[188:191], v2, s[4:7], s54 offen nt
    s_add_u32 s54, s54, 4096
    s_waitcnt vmcnt(9)
    buffer_load_dwordx4 v[192:195], v2, s[4:7], s54 offen nt
    s_add_u32 s54, s54, 4096
    s_waitcnt vmcnt(9)
    buffer_load_dwordx4 v[196:199], v2, s[4:7], s54 offen nt
    s_add_u32 s54, s54, 4096
    s_waitcnt vmcnt(9)
    buffer_load_dwordx4 v[200:203], v2, s[4:7], s54 offen nt
    s_add_u32 s54, s54, 4096
    s_waitcnt vmcnt(9)
    buffer_load_dwordx4 v[204:207], v2, s[4:7], s54 offen nt
    s_add_u32 s54, s54, 4096
    s_waitcnt vmcnt(9)
    buffer_load_dwordx4 v[208:211], v2, s[4:7], s54 offen nt
    s_add_u32 s54, s54, 4096
    s_waitcnt vmcnt(9)
    buffer_load_dwordx4 v[212:215], v2, s[4:7], s54 offen nt
    s_add_u32 s54, s54, 4096
    s_waitcnt vmcnt(9)
    buffer_load_dwordx4 v[216:219], v2, s[4:7], s54 offen nt
    s_add_u32 s54, s54, 4096
    s_waitcnt vmcnt(9)
    buffer_load_dwordx4 v[220:223], v2, s[4:7], s54 offen nt
    s_add_u32 s54, s54, 4096
    s_waitcnt vmcnt(9)
    buffer_load_dwordx4 v[224:227], v2, s[4:7], s54 offen nt
    s_add_u32 s54, s54, 4096
    s_waitcnt vmcnt(9)
    buffer_load_dwordx4 v[228:231], v2, s[4:7], s54 offen nt
    s_add_u32 s54, s54, 4096
    s_waitcnt vmcnt(9)
    buffer_load_dwordx4 v[232:235], v2, s[4:7], s54 offen nt
    s_add_u32 s54, s54, 4096
    s_waitcnt vmcnt(9)
    buffer_load_dwordx4 v[236:239], v2, s[4:7], s54 offen nt
    s_add_u32 s54, s54, 4096
    s_waitcnt vmcnt(9)
    buffer_load_dwordx4 v[240:243], v2, s[4:7], s54 offen nt
    s_add_u32 s54, s54, 4096
    s_waitcnt vmcnt(9)
    buffer_load_dwordx4 v[244:247], v2, s[4:7], s54 offen nt
    s_add_u32 s54, s54, 4096
    s_waitcnt vmcnt(9)
    buffer_load_dwordx4 v[248:251], v2, s[4:7], s54 offen nt
    s_add_u32 s54, s54, 4096
    s_waitcnt vmcnt(9)
    buffer_load_dwordx4 v[252:255], v2, s[4:7], s54 offen nt
    s_setprio 1
    s_lshl_b32 s55, s50, 12
    s_mov_b32 s56, 0xaaaaaaaa
    s_mov_b32 s57, 0xaaaaaaaa
    s_mov_b32 s58, 0xcccccccc
    s_mov_b32 s59, 0xcccccccc
    s_waitcnt lgkmcnt(0)
    s_add_u32 s97, s97, 1
    s_barrier
    s_cmp_lg_u32 s3, 0
    s_cbranch_scc1 L_qwait
    buffer_load_dword v28, v24, s[40:43], 0 offen sc1
    s_mov_b32 s62, 0
    s_branch L_qpoll_go
L_qpoll:
    s_sleep 4
    s_add_u32 s62, s62, 1
    s_cmp_gt_u32 s62, 1000000
    s_cbranch_scc1 L_qpoll_ok
L_qpoll_go:
    buffer_load_dwordx4 v[8:11], v2, s[44:47], s55 offen offset:0 sc1
    buffer_load_dwordx4 v[12:15], v2, s[44:47], s55 offen offset:1024 sc1
    buffer_load_dwordx4 v[16:19], v2, s[44:47], s55 offen offset:2048 sc1
    buffer_load_dwordx4 v[20:23], v2, s[44:47], s55 offen offset:3072 sc1
    s_waitcnt vmcnt(0)
    v_xor_b32 v7, s97, v9
    v_xor_b32 v1, s97, v11
    v_or_b32 v7, v7, v1
    v_xor_b32 v1, s97, v13
    v_or_b32 v7, v7, v1
    v_xor_b32 v1, s97, v15
    v_or_b32 v7, v7, v1
    v_xor_b32 v1, s97, v17
    v_or_b32 v7, v7, v1
    v_xor_b32 v1, s97, v19
    v_or_b32 v7, v7, v1
    v_xor_b32 v1, s97, v21
    v_or_b32 v7, v7, v1
    v_xor_b32 v1, s97, v23
    v_or_b32 v7, v7, v1
    v_cmp_ne_u32 vcc, 0, v7
    s_cbranch_vccnz L_qpoll
L_qpoll_ok:
    v_lshlrev_b32 v30, 16, v8
    v_and_b32 v31, 0xffff0000, v8
    v_lshlrev_b32 v34, 16, v12
    v_and_b32 v35, 0xffff0000, v12
    v_pk_add_f32 v[30:31], v[30:31], v[34:35]
    v_lshlrev_b32 v34, 16, v16
    v_and_b32 v35, 0xffff0000, v16
    v_pk_add_f32 v[30:31], v[30:31], v[34:35]
    v_lshlrev_b32 v34, 16, v20
    v_and_b32 v35, 0xffff0000, v20
    v_pk_add_f32 v[30:31], v[30:31], v[34:35]
    v_lshlrev_b32 v32, 16, v10
    v_and_b32 v33, 0xffff0000, v10
    v_lshlrev_b32 v34, 16, v14
    v_and_b32 v35, 0xffff0000, v14
    v_pk_add_f32 v[32:33], v[32:33], v[34:35]
    v_lshlrev_b32 v34, 16, v18
    v_and_b32 v35, 0xffff0000, v18
    v_pk_add_f32 v[32:33], v[32:33], v[34:35]
    v_lshlrev_b32 v34, 16, v22
    v_and_b32 v35, 0xffff0000, v22
    v_pk_add_f32 v[32:33], v[32:33], v[34:35]
    v_mov_b32 v34, v30
    v_mov_b32 v35, v31
    v_mov_b32 v36, v32
    v_mov_b32 v37, v33
    s_nop 1
    v_permlane32_swap_b32 v34, v30
    v_permlane32_swap_b32 v35, v31
    v_permlane32_swap_b32 v36, v32
    v_permlane32_swap_b32 v37, v33
    v_pk_add_f32 v[30:31], v[30:31], v[34:35]
    v_pk_add_f32 v[32:33], v[32:33], v[36:37]
    v_cvt_pk_bf16_f32 v30, v30, v31
    v_cvt_pk_bf16_f32 v31, v32, v33
    v_and_b32 v5, 31, v0
    v_lshlrev_b32 v5, 3, v5
    ds_write_b64 v5, v[30:31] offset:2304
    ds_write_b32 v24, v25 offset:2076
L_qwait:
    v_lshlrev_b32 v5, 4, v4
    s_mov_b32 s62, 0
    s_waitcnt vmcnt(0)
L_qspin:
    ds_read_b32 v7, v24 offset:2076
    ds_read_b128 v[8:11], v5 offset:2304
    s_add_u32 s62, s62, 1
    s_cmp_gt_u32 s62, 8000000
    s_cbranch_scc1 L_qgot
    s_waitcnt lgkmcnt(0)
    v_cmp_eq_u32 vcc, 0, v7
    s_cbranch_vccz L_qgot
    s_sleep 2
    s_branch L_qspin
L_qgot:
    s_waitcnt lgkmcnt(0)
    v_dot2_f32_bf16 v128, v128, v8, 0
    v_dot2_f32_bf16 v132, v132, v8, 0
    v_dot2_f32_bf16 v136, v136, v8, 0
    v_dot2_f32_bf16 v140, v140, v8, 0
    v_dot2_f32_bf16 v128, v129, v9, v128
    v_dot2_f32_bf16 v132, v133, v9, v132
    v_dot2_f32_bf16 v136, v137, v9, v136
    v_dot2_f32_bf16 v140, v141, v9, v140
    v_dot2_f32_bf16 v128, v130, v10, v128
    v_dot2_f32_bf16 v132, v134, v10, v132
    v_dot2_f32_bf16 v136, v138, v10, v136
    v_dot2_f32_bf16 v140, v142, v10, v140
    v_dot2_f32_bf16 v128, v131, v11, v128
    v_dot2_f32_bf16 v132, v135, v11, v132
    v_dot2_f32_bf16 v136, v139, v11, v136
    v_dot2_f32_bf16 v140, v143, v11, v140
    v_dot2_f32_bf16 v144, v144, v8, 0
    v_dot2_f32_bf16 v148, v148, v8, 0
    v_dot2_f32_bf16 v152, v152, v8, 0
    v_dot2_f32_bf16 v156, v156, v8, 0
    v_dot2_f32_bf16 v144, v145, v9, v144
    v_dot2_f32_bf16 v148, v149, v9, v148
    v_dot2_f32_bf16 v152, v153, v9, v152
    v_dot2_f32_bf16 v156, v157, v9, v156
    v_dot2_f32_bf16 v144, v146, v10, v144
    v_dot2_f32_bf16 v148, v150, v10, v148
    v_dot2_f32_bf16 v152, v154, v10, v152
    v_dot2_f32_bf16 v156, v158, v10, v156
    v_dot2_f32_bf16 v144, v147, v11, v144
    v_dot2_f32_bf16 v148, v151, v11, v148
    v_dot2_f32_bf16 v152, v155, v11, v152
    v_dot2_f32_bf16 v156, v159, v11, v156
    v_dot2_f32_bf16 v160, v160, v8, 0
    v_dot2_f32_bf16 v164, v164, v8, 0
    v_dot2_f32_bf16 v168, v168, v8, 0
    v_dot2_f32_bf16 v172, v172, v8, 0
    v_dot2_f32_bf16 v160, v161, v9, v160
    v_dot2_f32_bf16 v164, v165, v9, v164
    v_dot2_f32_bf16 v168, v169, v9, v168
    v_dot2_f32_bf16 v172, v173, v9, v172
    v_dot2_f32_bf16 v160, v162, v10, v160
    v_dot2_f32_bf16 v164, v166, v10, v164
    v_dot2_f32_bf16 v168, v170, v10, v168
    v_dot2_f32_bf16 v172, v174, v10, v172
    v_dot2_f32_bf16 v160, v163, v11, v160
    v_dot2_f32_bf16 v164, v167, v11, v164
    v_dot2_f32_bf16 v168, v171, v11, v168
    v_dot2_f32_bf16 v172, v175, v11, v172
    v_dot2_f32_bf16 v176, v176, v8, 0
    v_dot2_f32_bf16 v180, v180, v8, 0
    v_dot2_f32_bf16 v184, v184, v8, 0
    v_dot2_f32_bf16 v188, v188, v8, 0
    v_dot2_f32_bf16 v176, v177, v9, v176
    v_dot2_f32_bf16 v180, v181, v9, v180
    v_dot2_f32_bf16 v184, v185, v9, v184
    v_dot2_f32_bf16 v188, v189, v9, v188
    v_dot2_f32_bf16 v176, v178, v10, v176
    v_dot2_f32_bf16 v180, v182, v10, v180
    v_dot2_f32_bf16 v184, v186, v10, v184
    v_dot2_f32_bf16 v188, v190, v10, v188
    v_dot2_f32_bf16 v176, v179, v11, v176
    v_dot2_f32_bf16 v180, v183, v11, v180
    v_dot2_f32_bf16 v184, v187, v11, v184
    v_dot2_f32_bf16 v188, v191, v11, v188
    v_dot2_f32_bf16 v192, v192, v8, 0
    v_dot2_f32_bf16 v196, v196, v8, 0
    v_dot2_f32_bf16 v200, v200, v8, 0
    v_dot2_f32_bf16 v204, v204, v8, 0
    v_dot2_f32_bf16 v192, v193, v9, v192
    v_dot2_f32_bf16 v196, v197, v9, v196
    v_dot2_f32_bf16 v200, v201, v9, v200
    v_dot2_f32_bf16 v204, v205, v9, v204
    v_dot2_f32_bf16 v192, v194, v10, v192
    v_dot2_f32_bf16 v196, v198, v10, v196
    v_dot2_f32_bf16 v200, v202, v10, v200
    v_dot2_f32_bf16 v204, v206, v10, v204
    v_dot2_f32_bf16 v192, v195, v11, v192
    v_dot2_f32_bf16 v196, v199, v11, v196
    v_dot2_f32_bf16 v200, v203, v11, v200
    v_dot2_f32_bf16 v204, v207, v11, v204
    v_dot2_f32_bf16 v208, v208, v8, 0
    v_dot2_f32_bf16 v212, v212, v8, 0
    v_dot2_f32_bf16 v216, v216, v8, 0
    v_dot2_f32_bf16 v220, v220, v8, 0
    v_dot2_f32_bf16 v208, v209, v9, v208
    v_dot2_f32_bf16 v212, v213, v9, v212
    v_dot2_f32_bf16 v216, v217, v9, v216
    v_dot2_f32_bf16 v220, v221, v9, v220
    v_dot2_f32_bf16 v208, v210, v10, v208
    v_dot2_f32_bf16 v212, v214, v10, v212
    v_dot2_f32_bf16 v216, v218, v10, v216
    v_dot2_f32_bf16 v220, v222, v10, v220
    v_dot2_f32_bf16 v208, v211, v11, v208
    v_dot2_f32_bf16 v212, v215, v11, v212
    v_dot2_f32_bf16 v216, v219, v11, v216
    v_dot2_f32_bf16 v220, v223, v11, v220
    v_dot2_f32_bf16 v224, v224, v8, 0
    v_dot2_f32_bf16 v228, v228, v8, 0
    v_dot2_f32_bf16 v232, v232, v8, 0
    v_dot2_f32_bf16 v236, v236, v8, 0
    v_dot2_f32_bf16 v224, v225, v9, v224
    v_dot2_f32_bf16 v228, v229, v9, v228
    v_dot2_f32_bf16 v232, v233, v9, v232
    v_dot2_f32_bf16 v236, v237, v9, v236
    v_dot2_f32_bf16 v224, v226, v10, v224
    v_dot2_f32_bf16 v228, v230, v10, v228
    v_dot2_f32_bf16 v232, v234, v10, v232
    v_dot2_f32_bf16 v236, v238, v10, v236
    v_dot2_f32_bf16 v224, v227, v11, v224
    v_dot2_f32_bf16 v228, v231, v11, v228
    v_dot2_f32_bf16 v232, v235, v11, v232
    v_dot2_f32_bf16 v236, v239, v11, v236
    v_dot2_f32_bf16 v240, v240, v8, 0
    v_dot2_f32_bf16 v244, v244, v8, 0
    v_dot2_f32_bf16 v248, v248, v8, 0
    v_dot2_f32_bf16 v252, v252, v8, 0
    v_dot2_f32_bf16 v240, v241, v9, v240
    v_dot2_f32_bf16 v244, v245, v9, v244
    v_dot2_f32_bf16 v248, v249, v9, v248
    v_dot2_f32_bf16 v252, v253, v9, v252
    v_dot2_f32_bf16 v240, v242, v10, v240
    v_dot2_f32_bf16 v244, v246, v10, v244
    v_dot2_f32_bf16 v248, v250, v10, v248
    v_dot2_f32_bf16 v252, v254, v10, v252
    v_dot2_f32_bf16 v240, v243, v11, v240
    v_dot2_f32_bf16 v244, v247, v11, v244
    v_dot2_f32_bf16 v248, v251, v11, v248
    v_dot2_f32_bf16 v252, v255, v11, v252
    s_nop 2
    v_add_f32_dpp v128, v128, v128 row_ror:8 row_mask:0xf bank_mask:0x3
    v_add_f32_dpp v128, v160, v160 row_ror:8 row_mask:0xf bank_mask:0xc
    v_add_f32_dpp v132, v132, v132 row_ror:8 row_mask:0xf bank_mask:0x3
    v_add_f32_dpp v132, v164, v164 row_ror:8 row_mask:0xf bank_mask:0xc
    v_add_f32_dpp v136, v136, v136 row_ror:8 row_mask:0xf bank_mask:0x3
    v_add_f32_dpp v136, v168, v168 row_ror:8 row_mask:0xf bank_mask:0xc
    v_add_f32_dpp v140, v140, v140 row_ror:8 row_mask:0xf bank_mask:0x3
    v_add_f32_dpp v140, v172, v172 row_ror:8 row_mask:0xf bank_mask:0xc
    v_add_f32_dpp v144, v144, v144 row_ror:8 row_mask:0xf bank_mask:0x3
    v_add_f32_dpp v144, v176, v176 row_ror:8 row_mask:0xf bank_mask:0xc
    v_add_f32_dpp v148, v148, v148 row_ror:8 row_mask:0xf bank_mask:0x3
    v_add_f32_dpp v148, v180, v180 row_ror:8 row_mask:0xf bank_mask:0xc
    v_add_f32_dpp v152, v152, v152 row_ror:8 row_mask:0xf bank_mask:0x3
    v_add_f32_dpp v152, v184, v184 row_ror:8 row_mask:0xf bank_mask:0xc
    v_add_f32_dpp v156, v156, v156 row_ror:8 row_mask:0xf bank_mask:0x3
    v_add_f32_dpp v156, v188, v188 row_ror:8 row_mask:0xf bank_mask:0xc
    v_add_f32_dpp v192, v192, v192 row_ror:8 row_mask:0xf bank_mask:0x3
    v_add_f32_dpp v192, v224, v224 row_ror:8 row_mask:0xf bank_mask:0xc
    v_add_f32_dpp v196, v196, v196 row_ror:8 row_mask:0xf bank_mask:0x3
    v_add_f32_dpp v196, v228, v228 row_ror:8 row_mask:0xf bank_mask:0xc
    v_add_f32_dpp v200, v200, v200 row_ror:8 row_mask:0xf bank_mask:0x3
    v_add_f32_dpp v200, v232, v232 row_ror:8 row_mask:0xf bank_mask:0xc
    v_add_f32_dpp v204, v204, v204 row_ror:8 row_mask:0xf bank_mask:0x3
    v_add_f32_dpp v204, v236, v236 row_ror:8 row_mask:0xf bank_mask:0xc
    v_add_f32_dpp v208, v208, v208 row_ror:8 row_mask:0xf bank_mask:0x3
    v_add_f32_dpp v208, v240, v240 row_ror:8 row_mask:0xf bank_mask:0xc
    v_add_f32_dpp v212, v212, v212 row_ror:8 row_mask:0xf bank_mask:0x3
    v_add_f32_dpp v212, v244, v244 row_ror:8 row_mask:0xf bank_mask:0xc
    v_add_f32_dpp v216, v216, v216 row_ror:8 row_mask:0xf bank_mask:0x3
    v_add_f32_dpp v216, v248, v248 row_ror:8 row_mask:0xf bank_mask:0xc
    v_add_f32_dpp v220, v220, v220 row_ror:8 row_mask:0xf bank_mask:0x3
    v_add_f32_dpp v220, v252, v252 row_ror:8 row_mask:0xf bank_mask:0xc
    v_add_f32_dpp v128, v128, v128 row_half_mirror row_mask:0xf bank_mask:0x5
    v_add_f32_dpp v128, v144, v144 row_half_mirror row_mask:0xf bank_mask:0xa
    v_add_f32_dpp v132, v132, v132 row_half_mirror row_mask:0xf bank_mask:0x5
    v_add_f32_dpp v132, v148, v148 row_half_mirror row_mask:0xf bank_mask:0xa
    v_add_f32_dpp v136, v136, v136 row_half_mirror row_mask:0xf bank_mask:0x5
    v_add_f32_dpp v136, v152, v152 row_half_mirror row_mask:0xf bank_mask:0xa
    v_add_f32_dpp v140, v140, v140 row_half_mirror row_mask:0xf bank_mask:0x5
    v_add_f32_dpp v140, v156, v156 row_half_mirror row_mask:0xf bank_mask:0xa
    v_add_f32_dpp v192, v192, v192 row_half_mirror row_mask:0xf bank_mask:0x5
    v_add_f32_dpp v192, v208, v208 row_half_mirror row_mask:0xf bank_mask:0xa
    v_add_f32_dpp v196, v196, v196 row_half_mirror row_mask:0xf bank_mask:0x5
    v_add_f32_dpp v196, v212, v212 row_half_mirror row_mask:0xf bank_mask:0xa
    v_add_f32_dpp v200, v200, v200 row_half_mirror row_mask:0xf bank_mask:0x5
    v_add_f32_dpp v200, v216, v216 row_half_mirror row_mask:0xf bank_mask:0xa
    v_add_f32_dpp v204, v204, v204 row_half_mirror row_mask:0xf bank_mask:0x5
    v_add_f32_dpp v204, v220, v220 row_half_mirror row_mask:0xf bank_mask:0xa
    v_cndmask_b32 v12, v128, v132, s[56:57]
    v_cndmask_b32 v13, v132, v128, s[56:57]
    v_cndmask_b32 v14, v136, v140, s[56:57]
    v_cndmask_b32 v15, v140, v136, s[56:57]
    v_cndmask_b32 v16, v192, v196, s[56:57]
    v_cndmask_b32 v17, v196, v192, s[56:57]
    v_cndmask_b32 v18, v200, v204, s[56:57]
    v_cndmask_b32 v19, v204, v200, s[56:57]
    s_nop 0
    v_add_f32_dpp v12, v13, v12 quad_perm:[1,0,3,2] row_mask:0xf bank_mask:0xf
    v_add_f32_dpp v14, v15, v14 quad_perm:[1,0,3,2] row_mask:0xf bank_mask:0xf
    v_add_f32_dpp v16, v17, v16 quad_perm:[1,0,3,2] row_mask:0xf bank_mask:0xf
    v_add_f32_dpp v18, v19, v18 quad_perm:[1,0,3,2] row_mask:0xf bank_mask:0xf
    v_cndmask_b32 v13, v12, v14, s[58:59]
    v_cndmask_b32 v15, v14, v12, s[58:59]
    v_cndmask_b32 v17, v16, v18, s[58:59]
    v_cndmask_b32 v19, v18, v16, s[58:59]
    s_nop 0
    v_add_f32_dpp v12, v15, v13 quad_perm:[2,3,0,1] row_mask:0xf bank_mask:0xf
    v_add_f32_dpp v13, v19, v17 quad_perm:[2,3,0,1] row_mask:0xf bank_mask:0xf
    v_mul_f32 v12, 0x3e0293ee, v12
    v_mul_f32 v13, 0x3e0293ee, v13
    v_max_f32 v14, v12, v13
    s_nop 1
    v_max_f32_dpp v14, v14, v14 row_ror:8 row_mask:0xf bank_mask:0xf
    s_nop 1
    v_max_f32_dpp v14, v14, v14 row_ror:4 row_mask:0xf bank_mask:0xf
    s_nop 1
    v_max_f32_dpp v14, v14, v14 row_ror:2 row_mask:0xf bank_mask:0xf
    s_nop 1
    v_max_f32_dpp v14, v14, v14 row_ror:1 row_mask:0xf bank_mask:0xf
    s_nop 1
    v_max_f32_dpp v14, v14, v14 row_bcast:15 row_mask:0xa bank_mask:0xf
    s_nop 1
    v_max_f32_dpp v14, v14, v14 row_bcast:31 row_mask:0xc bank_mask:0xf
    s_nop 0
    v_readlane_b32 s60, v14, 63
    s_nop 1
    v_subrev_f32 v12, s60, v12
    v_subrev_f32 v13, s60, v13
    v_exp_f32 v12, v12
    v_exp_f32 v13, v13
    s_lshl_b32 s55, s53, 9
    v_add_f32 v14, v12, v13
    v_cvt_pk_bf16_f32 v12, v12, v12
    v_cvt_pk_bf16_f32 v13, v13, v13
    v_lshlrev_b32 v5, 7, v3
    v_lshl_add_u32 v5, v4, 2, v5
    v_add_u32 v5, s55, v5
    ds_write_b32 v5, v12 offset:0
    ds_write_b32 v5, v13 offset:64
    s_nop 1
    v_add_f32_dpp v14, v14, v14 row_ror:8 row_mask:0xf bank_mask:0xf
    s_nop 1
    v_add_f32_dpp v14, v14, v14 row_ror:4 row_mask:0xf bank_mask:0xf
    s_nop 1
    v_add_f32_dpp v14, v14, v14 row_ror:2 row_mask:0xf bank_mask:0xf
    s_nop 1
    v_add_f32_dpp v14, v14, v14 row_ror:1 row_mask:0xf bank_mask:0xf
    s_nop 1
    v_add_f32_dpp v14, v14, v14 row_bcast:15 row_mask:0xa bank_mask:0xf
    s_nop 1
    v_add_f32_dpp v14, v14, v14 row_bcast:31 row_mask:0xc bank_mask:0xf
    s_nop 0
    v_readlane_b32 s61, v14, 63
    s_cmp_lg_u32 s3, 0
    s_cbranch_scc1 L_flagok
    s_mov_b32 s62, 0
L_flagchk:
    v_cmp_gt_u32 vcc, 32, v28
    s_cbranch_vccz L_flagok
    s_add_u32 s62, s62, 1
    s_cmp_gt_u32 s62, 1000000
    s_cbranch_scc1 L_flagok
    s_sleep 8
    buffer_load_dword v28, v24, s[40:43], 0 offen sc1
    s_waitcnt vmcnt(0)
    s_branch L_flagchk
L_flagok:
    s_lshl_b32 s55, s53, 3
    v_mov_b32 v5, s55
    v_mov_b32 v12, s60
    v_mov_b32 v13, s61
    s_mov_b64 exec, 1
    ds_write_b64 v5, v[12:13] offset:2080
    s_mov_b64 exec, 1
    ds_add_rtn_u32 v7, v24, v25 offset:2068
    s_waitcnt lgkmcnt(0)
    v_readfirstlane_b32 s57, v7
    s_mov_b64 exec, -1
    s_nop 2
    s_cmp_lt_u32 s57, 3
    s_cbranch_scc1 L_mlnotlast
    v_and_b32 v5, 3, v0
    v_lshlrev_b32 v6, 3, v5
    ds_read_b64 v[12:13], v6 offset:2080
    v_lshlrev_b32 v6, 2, v5
    s_waitcnt lgkmcnt(0)
    v_max_f32_dpp v14, v12, v12 quad_perm:[1,0,3,2] row_mask:0xf bank_mask:0xf
    s_nop 1
    v_max_f32_dpp v14, v14, v14 quad_perm:[2,3,0,1] row_mask:0xf bank_mask:0xf
    v_sub_f32 v12, v12, v14
    v_exp_f32 v12, v12
    s_nop 0
    v_mul_f32 v15, v12, v13
    ds_write_b32 v6, v12 offset:2048
    s_nop 0
    v_add_f32_dpp v15, v15, v15 quad_perm:[1,0,3,2] row_mask:0xf bank_mask:0xf
    s_nop 1
    v_add_f32_dpp v15, v15, v15 quad_perm:[2,3,0,1] row_mask:0xf bank_mask:0xf
    v_min_u32 v14, -2, v14
    v_min_u32 v15, -2, v15
    ds_write_b64 v24, v[14:15] offset:2112
L_mlnotlast:
    s_bitcmp1_b32 s48, 0
    s_cbranch_scc1 L_gd
    s_lshr_b32 s55, s49, 3
    s_lshl_b32 s63, s48, 1
    s_add_u32 s63, s63, s55
    s_lshl_b32 s55, s63, 2
    s_add_u32 s55, s55, s53
    s_lshl_b32 s90, s55, 16
    s_lshl_b32 s57, s51, 7
    s_add_u32 s90, s90, s57
    s_lshl_b32 s57, s53, 13
    s_add_u32 s57, s57, 12288
    s_mov_b32 m0, s57
    v_lshrrev_b32 v5, 3, v0
    v_lshrrev_b32 v7, 1, v5
    v_and_b32 v7, 2, v7
    v_lshlrev_b32 v5, 10, v5
    v_and_b32 v6, 7, v0
    v_xor_b32 v6, v6, v7
    v_lshl_add_u32 v38, v6, 4, v5
    v_xor_b32 v39, 64, v38
    s_waitcnt lgkmcnt(0)
    s_barrier
    s_barrier
    s_cmp_lg_u32 s3, 3
    s_cbranch_scc1 L_mlw
    ds_read_b64 v[12:13], v24 offset:2112
    s_lshl_b32 s60, s52, 7
    s_add_u32 s60, s60, 131072
    s_mov_b64 exec, 1
    s_waitcnt lgkmcnt(0)
    buffer_store_dwordx2 v[12:13], v24, s[44:47], s60 offen sc1
    s_mov_b64 exec, -1
L_mlw:
    buffer_load_dwordx4 v38, s[20:23], s90 offen nt lds
    s_add_u32 m0, m0, 1024
    s_add_u32 s90, s90, 8192
    buffer_load_dwordx4 v39, s[20:23], s90 offen nt lds
    s_add_u32 m0, m0, 1024
    s_add_u32 s90, s90, 8192
    buffer_load_dwordx4 v38, s[20:23], s90 offen nt lds
    s_add_u32 m0, m0, 1024
    s_add_u32 s90, s90, 8192
    buffer_load_dwordx4 v39, s[20:23], s90 offen nt lds
    s_add_u32 m0, m0, 1024
    s_add_u32 s90, s90, 8192
    buffer_load_dwordx4 v38, s[20:23], s90 offen nt lds
    s_add_u32 m0, m0, 1024
    s_add_u32 s90, s90, 8192
    buffer_load_dwordx4 v39, s[20:23], s90 offen nt lds
    s_add_u32 m0, m0, 1024
    s_add_u32 s90, s90, 8192
    buffer_load_dwordx4 v38, s[20:23], s90 offen nt lds
    s_add_u32 m0, m0, 1024
    s_add_u32 s90, s90, 8192
    buffer_load_dwordx4 v39, s[20:23], s90 offen nt lds
    v_bfe_u32 v6, v0, 2, 1
    v_and_b32 v7, 8, v0
    v_add_u32 v6, v6, v7
    v_bfe_u32 v7, v0, 4, 1
    v_lshl_add_u32 v6, v7, 2, v6
    v_bfe_u32 v7, v0, 5, 1
    v_lshl_add_u32 v6, v7, 4, v6
    v_lshlrev_b32 v6, 7, v6
    v_and_b32 v7, 3, v0
    v_lshl_add_u32 v6, v7, 3, v6
    v_add_u32 v6, s57, v6
    v_bfe_u32 v7, v0, 4, 1
    v_lshlrev_b32 v7, 5, v7
    v_xor_b32 v6, v6, v7
    v_bfe_u32 v7, v0, 3, 1
    v_lshlrev_b32 v7, 6, v7
    v_xor_b32 v34, v6, v7
    v_xor_b32 v35, 32, v34
    v_xor_b32 v36, 64, v34
    v_xor_b32 v37, 96, v34
    v_bfe_u32 v8, v0, 2, 1
    v_xor_b32 v8, v8, v3
    v_and_b32 v8, 1, v8
    v_lshlrev_b32 v8, 2, v8
    v_and_b32 v7, 3, v0
    v_add_lshl_u32 v8, v8, v7, 7
    s_lshr_b32 s55, s55, 1
    s_lshl_b32 s58, s55, 10
    s_add_u32 s58, s58, 131072
    v_and_b32 v5, 7, v4
    v_lshlrev_b32 v5, 8, v5
    v_lshl_add_u32 v5, v3, 5, v5
    v_lshrrev_b32 v7, 3, v4
    v_lshl_add_u32 v5, v7, 4, v5
    v_mul_u32_u24 v28, 0xaaaa, v7
    v_add_u32 v28, 0x4444, v28
    s_lshl_b32 s55, s55, 11
    s_and_b32 s56, s53, 1
    s_lshl_b32 s56, s56, 7
    s_add_u32 s55, s55, s56
    s_add_u32 s55, s55, 196608
    v_lshlrev_b32 v10, 5, v4
    v_and_b32 v7, 1, v3
    v_lshl_add_u32 v10, v7, 2, v10
    v_lshrrev_b32 v7, 1, v3
    v_lshl_add_u32 v10, v7, 9, v10
    s_lshl_b32 s56, s53, 3
    v_add_u32 v10, s56, v10
    v_lshlrev_b32 v11, 5, v0
    v_lshlrev_b32 v29, 1, v0
    s_lshl_b32 s56, s51, 4
    s_add_u32 s56, s56, s63
    s_lshl_b32 s56, s56, 7
    s_add_u32 s56, s56, 262144
    s_mov_b32 s88, 0x55555555
    s_mov_b32 s89, 0x55555555
    s_barrier
    s_barrier
    s_waitcnt vmcnt(4)
    ds_read_b64_tr_b16 v[64:65], v34 offset:0
    ds_read_b64_tr_b16 v[66:67], v34 offset:256
    ds_read_b64_tr_b16 v[72:73], v35 offset:0
    ds_read_b64_tr_b16 v[74:75], v35 offset:256
    ds_read_b64_tr_b16 v[80:81], v36 offset:0
    ds_read_b64_tr_b16 v[82:83], v36 offset:256
    ds_read_b64_tr_b16 v[88:89], v37 offset:0
    ds_read_b64_tr_b16 v[90:91], v37 offset:256
    s_waitcnt vmcnt(0)
    ds_read_b64_tr_b16 v[68:69], v34 offset:4096
    ds_read_b64_tr_b16 v[70:71], v34 offset:4352
    ds_read_b64_tr_b16 v[76:77], v35 offset:4096
    ds_read_b64_tr_b16 v[78:79], v35 offset:4352
    ds_read_b64_tr_b16 v[84:85], v36 offset:4096
    ds_read_b64_tr_b16 v[86:87], v36 offset:4352
    ds_read_b64_tr_b16 v[92:93], v37 offset:4096
    ds_read_b64_tr_b16 v[94:95], v37 offset:4352
    s_waitcnt lgkmcnt(0)
    s_mov_b32 s62, 0
    s_branch L_wpoll_go
L_wpoll:
    s_add_u32 s62, s62, 1
    s_cmp_gt_u32 s62, 1000000
    s_cbranch_scc1 L_wpoll_ok
L_wpoll_go:
    buffer_load_dwordx2 v[12:13], v8, s[44:47], s58 offen sc1
    buffer_load_dwordx4 v[56:59], v5, s[44:47], s55 offen sc1
    v_mov_b32 v40, 0
    v_mov_b32 v41, 0
    v_mov_b32 v42, 0
    v_mov_b32 v43, 0
    v_mov_b32 v44, 0
    v_mov_b32 v45, 0
    v_mov_b32 v46, 0
    v_mov_b32 v47, 0
    v_mov_b32 v48, 0
    v_mov_b32 v49, 0
    v_mov_b32 v50, 0
    v_mov_b32 v51, 0
    v_mov_b32 v52, 0
    v_mov_b32 v53, 0
    v_mov_b32 v54, 0
    v_mov_b32 v55, 0
    s_waitcnt vmcnt(0)
    v_smfmac_f32_16x16x64_bf16 v[40:43], v[56:59], v[64:71], v28
    v_max_f32_dpp v15, v12, v12 row_ror:4 row_mask:0xf bank_mask:0xf
    v_max3_u32 v7, v12, v13, v56
    v_max3_u32 v7, v7, v57, v58
    v_max_f32_dpp v15, v15, v15 quad_perm:[1,0,3,2] row_mask:0xf bank_mask:0xf
    v_smfmac_f32_16x16x64_bf16 v[44:47], v[56:59], v[72:79], v28
    v_max_u32 v7, v7, v59
    v_max_f32_dpp v15, v15, v15 quad_perm:[2,3,0,1] row_mask:0xf bank_mask:0xf
    v_cmp_eq_u32 vcc, -1, v7
    s_cbranch_vccnz L_wpoll
L_wpoll_ok:
    v_sub_f32 v12, v12, v15
    v_exp_f32 v12, v12
    v_smfmac_f32_16x16x64_bf16 v[48:51], v[56:59], v[80:87], v28
    v_mul_f32 v13, v12, v13
    v_mov_b32_dpp v12, v12 row_ror:4 row_mask:0xf bank_mask:0xa
    v_smfmac_f32_16x16x64_bf16 v[52:55], v[56:59], v[88:95], v28
    v_add_f32_dpp v13, v13, v13 row_ror:4 row_mask:0xf bank_mask:0xf
    v_mov_b32_dpp v30, v12 quad_perm:[0,0,0,0] row_mask:0xf bank_mask:0xf
    v_mov_b32_dpp v31, v12 quad_perm:[1,1,1,1] row_mask:0xf bank_mask:0xf
    v_add_f32_dpp v13, v13, v13 quad_perm:[1,0,3,2] row_mask:0xf bank_mask:0xf
    v_mov_b32_dpp v32, v12 quad_perm:[2,2,2,2] row_mask:0xf bank_mask:0xf
    v_mov_b32_dpp v33, v12 quad_perm:[3,3,3,3] row_mask:0xf bank_mask:0xf
    v_add_f32_dpp v13, v13, v13 quad_perm:[2,3,0,1] row_mask:0xf bank_mask:0xf
    v_pk_mul_f32 v[40:41], v[40:41], v[30:31]
    v_rcp_f32 v13, v13
    v_pk_mul_f32 v[44:45], v[44:45], v[30:31]
    v_pk_fma_f32 v[40:41], v[42:43], v[32:33], v[40:41]
    v_pk_fma_f32 v[44:45], v[46:47], v[32:33], v[44:45]
    v_add_f32 v40, v40, v41
    v_add_f32 v44, v44, v45
    v_pk_mul_f32 v[48:49], v[48:49], v[30:31]
    v_pk_mul_f32 v[52:53], v[52:53], v[30:31]
    v_permlane32_swap_b32 v40, v44
    v_pk_fma_f32 v[48:49], v[50:51], v[32:33], v[48:49]
    v_pk_fma_f32 v[52:53], v[54:55], v[32:33], v[52:53]
    v_add_f32 v48, v48, v49
    v_add_f32 v52, v52, v53
    v_add_f32 v40, v40, v44
    v_mul_f32 v40, v40, v13
    v_permlane32_swap_b32 v48, v52
    ds_write_b32 v10, v40 offset:4608
    v_add_f32 v48, v48, v52
    v_mul_f32 v48, v48, v13
    ds_write_b32 v10, v48 offset:5632
    s_cmp_lg_u32 s3, 0
    s_waitcnt lgkmcnt(0)
    s_barrier
    s_cbranch_scc1 L_fin
    ds_read_b128 v[12:15], v11 offset:4608
    ds_read_b128 v[16:19], v11 offset:4624
    s_waitcnt lgkmcnt(0)
    v_pk_add_f32 v[12:13], v[12:13], v[14:15]
    v_pk_add_f32 v[16:17], v[16:17], v[18:19]
    v_pk_add_f32 v[12:13], v[12:13], v[16:17]
    v_add_f32 v12, v12, v13
    s_nop 1
    v_mov_b32_dpp v13, v12 quad_perm:[1,0,3,2] row_mask:0xf bank_mask:0xf
    s_mov_b64 exec, s[88:89]
    v_cvt_pk_bf16_f32 v12, v12, v13
    v_min_u32 v12, -2, v12
    buffer_store_dword v12, v29, s[44:47], s56 offen sc1
    s_branch L_fin
L_gd:
    s_lshl_b32 s55, s49, 2
    s_add_u32 s55, s55, s53
    s_mul_i32 s57, s55, 12288
    s_and_b32 s60, s48, 6
    s_lshl_b32 s60, s60, 7
    s_add_u32 s57, s57, s60
    v_lshrrev_b32 v8, 4, v0
    v_lshlrev_b32 v8, 10, v8
    v_and_b32 v7, 15, v0
    v_lshl_add_u32 v8, v7, 4, v8
    v_add_u32 v8, s57, v8
    v_add_u32 v9, 4096, v8
    v_add_u32 v10, 8192, v8
    s_waitcnt lgkmcnt(0)
    s_barrier
    s_barrier
    s_cmp_lg_u32 s3, 3
    s_cbranch_scc1 L_mlg
    ds_read_b64 v[12:13], v24 offset:2112
    s_lshl_b32 s60, s52, 7
    s_add_u32 s60, s60, 131072
    s_mov_b64 exec, 1
    s_waitcnt lgkmcnt(0)
    buffer_store_dwordx2 v[12:13], v24, s[44:47], s60 offen sc1
    s_mov_b64 exec, -1
L_mlg:
    s_cmp_ge_u32 s49, 24
    s_cbranch_scc1 L_dstage
    s_lshr_b32 s55, s48, 1
    s_mul_i32 s99, s55, 22
    s_add_u32 s99, s99, s49
    s_cmp_eq_u32 s55, 3
    s_cselect_b32 s55, 20, 22
    s_cmp_lt_u32 s49, s55
    s_cbranch_scc1 L_gstage
    s_barrier
    s_barrier
    buffer_load_dwordx4 v[192:195], v8, s[32:35], 0 offen
    buffer_load_dwordx4 v[196:199], v9, s[32:35], 0 offen
    buffer_load_dwordx4 v[200:203], v10, s[32:35], 0 offen
    s_branch L_fin
L_gstage:
    s_bitcmp1_b32 s99, 0
    s_cselect_b32 s88, s28, s24
    s_cselect_b32 s89, s29, s25
    s_mov_b32 s90, 1409024
    s_mov_b32 s91, 0x20000
    v_and_b32 v5, 1, v4
    v_mov_b32 v6, 0xffff
    v_lshlrev_b32 v5, 4, v5
    v_lshlrev_b32 v6, v5, v6
    v_lshrrev_b32 v5, 1, v4
    v_cmp_eq_u32 vcc, 0, v5
    s_nop 1
    v_cndmask_b32 v20, 0, v6, vcc
    v_cmp_eq_u32 vcc, 1, v5
    s_nop 1
    v_cndmask_b32 v21, 0, v6, vcc
    v_cmp_eq_u32 vcc, 2, v5
    s_nop 1
    v_cndmask_b32 v22, 0, v6, vcc
    v_cmp_eq_u32 vcc, 3, v5
    s_nop 1
    v_cndmask_b32 v23, 0, v6, vcc
    v_lshrrev_b32 v5, 2, v0
    v_mul_u32_u24 v5, 2752, v5
    v_and_b32 v7, 3, v0
    v_lshl_add_u32 v5, v7, 4, v5
    s_mul_i32 s56, s53, 352256
    s_lshr_b32 s98, s99, 1
    s_lshl_b32 s57, s98, 6
    s_add_u32 s56, s56, s57
    s_lshl_b32 s57, s53, 13
    s_add_u32 s57, s57, 12288
    s_mov_b32 m0, s57
    v_and_b32 v6, 1, v3
    v_lshlrev_b32 v11, 4, v4
    v_lshl_add_u32 v11, v6, 3, v11
    s_lshl_b32 s58, s53, 8
    buffer_load_dwordx2 v[14:15], v11, s[16:19], s58 offen
    s_barrier
    s_barrier
    buffer_load_dwordx4 v5, s[88:91], s56 offen nt lds
    s_add_u32 m0, m0, 1024
    s_add_u32 s56, s56, 44032
    buffer_load_dwordx4 v5, s[88:91], s56 offen nt lds
    s_add_u32 m0, m0, 1024
    s_add_u32 s56, s56, 44032
    buffer_load_dwordx4 v5, s[88:91], s56 offen nt lds
    s_add_u32 m0, m0, 1024
    s_add_u32 s56, s56, 44032
    buffer_load_dwordx4 v5, s[88:91], s56 offen nt lds
    s_add_u32 m0, m0, 1024
    s_add_u32 s56, s56, 44032
    buffer_load_dwordx4 v5, s[88:91], s56 offen nt lds
    s_add_u32 m0, m0, 1024
    s_add_u32 s56, s56, 44032
    buffer_load_dwordx4 v5, s[88:91], s56 offen nt lds
    s_add_u32 m0, m0, 1024
    s_add_u32 s56, s56, 44032
    buffer_load_dwordx4 v5, s[88:91], s56 offen nt lds
    s_add_u32 m0, m0, 1024
    s_add_u32 s56, s56, 44032
    buffer_load_dwordx4 v5, s[88:91], s56 offen nt lds
    buffer_load_dwordx4 v[192:195], v8, s[32:35], 0 offen
    buffer_load_dwordx4 v[196:199], v9, s[32:35], 0 offen
    buffer_load_dwordx4 v[200:203], v10, s[32:35], 0 offen
    v_bfe_u32 v6, v0, 2, 1
    v_and_b32 v7, 8, v0
    v_add_u32 v6, v6, v7
    v_bfe_u32 v7, v0, 4, 1
    v_lshl_add_u32 v6, v7, 2, v6
    v_bfe_u32 v7, v0, 5, 1
    v_lshl_add_u32 v6, v7, 4, v6
    v_lshlrev_b32 v6, 6, v6
    v_and_b32 v7, 3, v0
    v_lshl_add_u32 v6, v7, 3, v6
    v_add_u32 v6, s57, v6
    v_and_b32 v7, 1, v0
    v_lshl_add_u32 v29, v3, 1, v7
    v_lshl_add_u32 v29, v29, 4, s58
    v_mul_u32_u24 v104, 0xaaaa, v7
    v_add_u32 v104, 0x4444, v104
    v_add_u32 v28, s58, v11
    v_and_b32 v32, 0x3f803f80, v20
    v_and_b32 v33, 0x3f803f80, v21
    v_and_b32 v34, 0x3f803f80, v22
    v_and_b32 v35, 0x3f803f80, v23
    v_lshrrev_b32 v5, 3, v4
    v_lshl_add_u32 v5, v5, 4, v3
    v_lshlrev_b32 v5, 7, v5
    v_and_b32 v7, 7, v4
    v_lshl_add_u32 v5, v7, 4, v5
    s_lshl_b32 s56, s53, 12
    s_add_u32 s56, s56, 262144
    v_lshlrev_b32 v30, 5, v4
    s_lshl_b32 s59, s53, 3
    v_add_u32 v30, s59, v30
    v_mov_b32 v31, s59
    v_lshlrev_b32 v43, 1, v0
    v_lshlrev_b32 v41, 5, v0
    s_lshl_b32 s58, s99, 7
    s_add_u32 s58, s58, 278528
    s_mov_b32 s60, 0xfff3fff3
    s_mov_b32 s61, 0xfff3fff3
    v_mov_b32 v108, 0x3f803f80
    v_mov_b32 v109, 0x3f803f80
    v_mov_b32 v110, 0x3f803f80
    v_mov_b32 v111, 0x3f803f80
    v_mov_b32 v112, 0x3f803f80
    v_mov_b32 v113, 0x3f803f80
    v_mov_b32 v114, 0x3f803f80
    v_mov_b32 v115, 0x3f803f80
    v_mov_b32 v16, 0
    v_mov_b32 v96, 0
    v_mov_b32 v17, 0
    v_mov_b32 v97, 0
    v_mov_b32 v18, 0
    v_mov_b32 v98, 0
    v_mov_b32 v19, 0
    v_mov_b32 v99, 0
    s_waitcnt vmcnt(7)
    ds_read_b64_tr_b16 v[64:65], v6 offset:0
    ds_read_b64_tr_b16 v[66:67], v6 offset:128
    ds_read_b64_tr_b16 v[68:69], v6 offset:2048
    ds_read_b64_tr_b16 v[70:71], v6 offset:2176
    ds_read_b64_tr_b16 v[80:81], v6 offset:32
    ds_read_b64_tr_b16 v[82:83], v6 offset:160
    ds_read_b64_tr_b16 v[84:85], v6 offset:2080
    ds_read_b64_tr_b16 v[86:87], v6 offset:2208
    v_lshlrev_b32 v100, 16, v14
    v_and_b32 v101, 0xffff0000, v14
    v_lshlrev_b32 v102, 16, v15
    v_and_b32 v103, 0xffff0000, v15
    s_waitcnt vmcnt(3)
    ds_read_b64_tr_b16 v[72:73], v6 offset:4096
    ds_read_b64_tr_b16 v[74:75], v6 offset:4224
    ds_read_b64_tr_b16 v[76:77], v6 offset:6144
    ds_read_b64_tr_b16 v[78:79], v6 offset:6272
    ds_read_b64_tr_b16 v[88:89], v6 offset:4128
    ds_read_b64_tr_b16 v[90:91], v6 offset:4256
    ds_read_b64_tr_b16 v[92:93], v6 offset:6176
    ds_read_b64_tr_b16 v[94:95], v6 offset:6304
    s_mov_b32 s62, 0
    s_branch L_gpoll_go
L_gpoll:
    s_add_u32 s62, s62, 1
    s_cmp_gt_u32 s62, 1000000
    s_cbranch_scc1 L_gpoll_ok
L_gpoll_go:
    buffer_load_dwordx4 v[44:47], v5, s[44:47], s56 offen offset:0 sc1
    buffer_load_dwordx4 v[48:51], v5, s[44:47], s56 offen offset:512 sc1
    buffer_load_dwordx4 v[52:55], v5, s[44:47], s56 offen offset:1024 sc1
    buffer_load_dwordx4 v[56:59], v5, s[44:47], s56 offen offset:1536 sc1
    s_waitcnt vmcnt(0)
    v_mfma_f32_16x16x32_bf16 v[12:15], v[32:35], v[44:47], v[100:103]
    v_max3_u32 v7, v44, v45, v46
    v_max3_u32 v7, v7, v47, v48
    v_mfma_f32_16x16x32_bf16 v[12:15], v[32:35], v[48:51], v[12:15]
    v_max3_u32 v7, v7, v49, v50
    v_max3_u32 v7, v7, v51, v52
    v_mfma_f32_16x16x32_bf16 v[12:15], v[32:35], v[52:55], v[12:15]
    v_max3_u32 v7, v7, v53, v54
    v_max3_u32 v7, v7, v55, v56
    v_mfma_f32_16x16x32_bf16 v[12:15], v[32:35], v[56:59], v[12:15]
    v_max3_u32 v7, v7, v57, v58
    v_max_u32 v7, v7, v59
    v_cmp_eq_u32 vcc, -1, v7
    s_cbranch_vccnz L_gpoll
L_gpoll_ok:
    s_mov_b32 exec_hi, 0
    s_nop 2
    v_cvt_pk_bf16_f32 v8, v12, v13
    v_cvt_pk_bf16_f32 v9, v14, v15
    ds_write_b64 v28, v[8:9] offset:6912
    s_mov_b64 exec, s[60:61]
    ds_read_b128 v[108:111], v29 offset:6912
    ds_read_b128 v[112:115], v29 offset:7040
    s_mov_b64 exec, -1
    v_lshlrev_b32 v12, 16, v8
    v_and_b32 v13, 0xffff0000, v8
    v_lshlrev_b32 v14, 16, v9
    v_and_b32 v15, 0xffff0000, v9
    v_add_f32 v10, v12, v13
    v_mul_f32 v11, v12, v12
    v_add_f32 v10, v10, v14
    v_fmac_f32 v11, v13, v13
    v_add_f32 v10, v10, v15
    v_fmac_f32 v11, v14, v14
    v_fmac_f32 v11, v15, v15
    s_cmp_lg_u32 s3, 0
    v_add_f32_dpp v10, v10, v10 row_ror:8 row_mask:0xf bank_mask:0xf
    v_add_f32_dpp v11, v11, v11 row_ror:8 row_mask:0xf bank_mask:0xf
    s_waitcnt lgkmcnt(1)
    v_smfmac_f32_16x16x64_bf16 v[16:19], v[108:111], v[64:71], v104
    v_add_f32_dpp v10, v10, v10 row_ror:4 row_mask:0xf bank_mask:0xf
    v_add_f32_dpp v11, v11, v11 row_ror:4 row_mask:0xf bank_mask:0xf
    v_smfmac_f32_16x16x64_bf16 v[96:99], v[108:111], v[80:87], v104
    v_add_f32_dpp v10, v10, v10 row_ror:2 row_mask:0xf bank_mask:0xf
    v_add_f32_dpp v11, v11, v11 row_ror:2 row_mask:0xf bank_mask:0xf
    s_waitcnt lgkmcnt(0)
    v_smfmac_f32_16x16x64_bf16 v[16:19], v[112:115], v[72:79], v104
    v_add_f32_dpp v10, v10, v10 row_ror:1 row_mask:0xf bank_mask:0xf
    v_add_f32_dpp v11, v11, v11 row_ror:1 row_mask:0xf bank_mask:0xf
    v_smfmac_f32_16x16x64_bf16 v[96:99], v[112:115], v[88:95], v104
    v_add_f32_dpp v10, v10, v10 row_bcast:15 row_mask:0xa bank_mask:0xf
    v_add_f32_dpp v11, v11, v11 row_bcast:15 row_mask:0xa bank_mask:0xf
    s_mov_b64 exec, 0x10000
    ds_write_b64 v31, v[10:11] offset:6656
    s_mov_b64 exec, 0xffff
    s_nop 0
    v_add_f32 v16, v16, v17
    v_add_f32 v17, v18, v19
    ds_write_b64 v30, v[16:17] offset:4608
    v_add_f32 v96, v96, v97
    v_add_f32 v97, v98, v99
    ds_write_b64 v30, v[96:97] offset:5120
    s_mov_b64 exec, -1
    s_waitcnt lgkmcnt(0)
    s_barrier
    s_cbranch_scc1 L_gtag
    ds_read_b128 v[8:11], v24 offset:6656
    ds_read_b128 v[12:15], v24 offset:6672
    ds_read_b128 v[16:19], v41 offset:4608
    ds_read_b128 v[20:23], v41 offset:4624
    s_mov_b32 exec_hi, 0
    s_bitcmp1_b32 s99, 0
    s_waitcnt lgkmcnt(2)
    v_pk_add_f32 v[8:9], v[8:9], v[10:11]
    v_pk_add_f32 v[12:13], v[12:13], v[14:15]
    v_pk_add_f32 v[8:9], v[8:9], v[12:13]
    v_mul_f32 v8, 0x3b000000, v8
    v_mov_b32 v10, 0x3727c5ac
    v_fmac_f32 v10, 0x3b000000, v9
    v_fma_f32 v9, -v8, v8, v10
    v_max_f32 v9, 0x3727c5ac, v9
    v_rsq_f32 v9, v9
    s_waitcnt lgkmcnt(0)
    v_pk_add_f32 v[16:17], v[16:17], v[18:19]
    v_pk_add_f32 v[20:21], v[20:21], v[22:23]
    v_pk_add_f32 v[16:17], v[16:17], v[20:21]
    v_fma_f32 v16, -v8, v17, v16
    v_mul_f32 v16, v16, v9
    s_cbranch_scc1 L_gup
    v_mul_f32 v16, 0xbfb8aa3b, v16
    v_exp_f32 v16, v16
    s_nop 0
    v_add_f32 v16, 1.0, v16
    v_rcp_f32 v16, v16
L_gup:
    s_nop 1
    v_mov_b32_dpp v17, v16 quad_perm:[1,0,3,2] row_mask:0xf bank_mask:0xf
    s_mov_b32 exec_lo, 0x55555555
    v_cvt_pk_bf16_f32 v40, v16, v17
    v_min_u32 v40, -2, v40
    buffer_store_dword v40, v43, s[44:47], s58 offen sc1
    s_branch L_fin
L_gtag:
    s_lshl_b32 s56, s99, 2
    s_add_u32 s56, s56, s3
    s_cmp_lg_u32 s56, 1
    s_cbranch_scc1 L_fin
    s_mov_b64 exec, 1
    s_mov_b32 s56, 294912
    v_mov_b32 v16, s97
    buffer_store_dword v16, v24, s[44:47], s56 offen sc1
    s_branch L_fin
L_dstage:
    s_and_b32 s99, s48, 6
    s_lshl_b32 s99, s99, 2
    s_add_u32 s99, s99, s49
    s_sub_u32 s99, s99, 24
    v_lshrrev_b32 v5, 1, v0
    v_lshlrev_b32 v5, 10, v5
    v_and_b32 v7, 1, v0
    v_lshl_add_u32 v105, v7, 4, v5
    s_mul_i32 s63, s53, 360448
    s_lshl_b32 s58, s99, 5
    s_add_u32 s63, s63, s58
    s_mul_i32 s57, s53, 11264
    s_add_u32 s57, s57, 12288
    s_mov_b32 m0, s57
    s_barrier
    s_barrier
    buffer_load_dwordx4 v[192:195], v8, s[32:35], 0 offen
    buffer_load_dwordx4 v[196:199], v9, s[32:35], 0 offen
    buffer_load_dwordx4 v[200:203], v10, s[32:35], 0 offen
    v_bfe_u32 v6, v0, 2, 1
    v_and_b32 v7, 8, v0
    v_add_u32 v6, v6, v7
    v_bfe_u32 v7, v0, 4, 1
    v_lshl_add_u32 v6, v7, 2, v6
    v_bfe_u32 v7, v0, 5, 1
    v_lshl_add_u32 v6, v7, 4, v6
    v_lshlrev_b32 v6, 5, v6
    v_and_b32 v7, 3, v0
    v_lshl_add_u32 v6, v7, 3, v6
    v_add_u32 v6, s57, v6
    s_mul_i32 s57, s53, 768
    v_and_b32 v7, 1, v0
    v_lshl_add_u32 v29, v3, 1, v7
    v_lshl_add_u32 v29, v29, 4, s57
    v_mul_u32_u24 v104, 0xaaaa, v7
    v_add_u32 v104, 0x4444, v104
    s_add_u32 s57, s57, 6912
    v_add_u32 v28, s57, v2
    s_mul_i32 s57, s53, 2816
    s_add_u32 s57, s57, 278528
    v_lshrrev_b32 v5, 2, v0
    v_lshlrev_b32 v5, 8, v5
    v_and_b32 v7, 3, v0
    v_lshl_add_u32 v5, v7, 4, v5
    v_add_u32 v5, s57, v5
    v_lshlrev_b32 v30, 4, v4
    s_lshl_b32 s56, s53, 2
    v_add_u32 v30, s56, v30
    v_lshlrev_b32 v31, 5, v0
    v_mov_b32 v12, 0
    v_mov_b32 v20, 0
    v_mov_b32 v16, 0
    v_mov_b32 v172, 0
    v_mov_b32 v13, 0
    v_mov_b32 v21, 0
    v_mov_b32 v17, 0
    v_mov_b32 v173, 0
    v_mov_b32 v14, 0
    v_mov_b32 v22, 0
    v_mov_b32 v18, 0
    v_mov_b32 v174, 0
    v_mov_b32 v15, 0
    v_mov_b32 v23, 0
    v_mov_b32 v19, 0
    v_mov_b32 v175, 0
    s_mov_b32 exec_lo, 0
    s_mov_b32 exec_hi, 0xf000
    ds_write_b128 v28, v[12:15]
    s_mov_b64 exec, -1
    s_cmp_eq_u32 s53, 3
    s_mov_b32 s88, -1
    s_mov_b32 s89, 0xfff
    s_cselect_b32 s89, 0xff, s89
    v_and_b32 v7, 7, v0
    v_lshlrev_b32 v9, 2, v7
    buffer_load_dword v8, v9, s[16:19], s58 offen
    v_lshrrev_b32 v7, 3, v0
    v_lshl_add_u32 v9, v7, 7, v9
    s_lshr_b32 s59, s99, 2
    s_lshl_b32 s59, s59, 11
    s_and_b32 s60, s99, 3
    s_lshl_b32 s60, s60, 5
    s_add_u32 s59, s59, s60
    s_add_u32 s59, s59, 262144
    s_mov_b32 s62, 0
    s_branch L_dcue_go
L_dcue:
    s_add_u32 s62, s62, 1
    s_cmp_gt_u32 s62, 1000000
    s_cbranch_scc1 L_dcue_ok
L_dcue_go:
    buffer_load_dword v10, v9, s[44:47], s59 offen sc1
    buffer_load_dword v11, v9, s[44:47], s59 offen offset:1024 sc1
    s_waitcnt vmcnt(0)
    v_max_u32 v7, v10, v11
    v_cmp_eq_u32 vcc, -1, v7
    s_cbranch_vccnz L_dcue
L_dcue_ok:
    buffer_load_dwordx4 v105, s[32:35], s63 offen lds
    s_add_u32 m0, m0, 1024
    s_add_u32 s63, s63, 32768
    buffer_load_dwordx4 v105, s[32:35], s63 offen lds
    s_add_u32 m0, m0, 1024
    s_add_u32 s63, s63, 32768
    buffer_load_dwordx4 v105, s[32:35], s63 offen lds
    s_add_u32 m0, m0, 1024
    s_add_u32 s63, s63, 32768
    buffer_load_dwordx4 v105, s[32:35], s63 offen lds
    s_add_u32 m0, m0, 1024
    s_add_u32 s63, s63, 32768
    buffer_load_dwordx4 v105, s[32:35], s63 offen lds
    s_add_u32 m0, m0, 1024
    s_add_u32 s63, s63, 32768
    buffer_load_dwordx4 v105, s[32:35], s63 offen lds
    s_add_u32 m0, m0, 1024
    s_add_u32 s63, s63, 32768
    buffer_load_dwordx4 v105, s[32:35], s63 offen lds
    s_add_u32 m0, m0, 1024
    s_add_u32 s63, s63, 32768
    buffer_load_dwordx4 v105, s[32:35], s63 offen lds
    s_add_u32 m0, m0, 1024
    s_add_u32 s63, s63, 32768
    buffer_load_dwordx4 v105, s[32:35], s63 offen lds
    s_add_u32 m0, m0, 1024
    s_add_u32 s63, s63, 32768
    buffer_load_dwordx4 v105, s[32:35], s63 offen lds
    s_add_u32 m0, m0, 1024
    s_add_u32 s63, s63, 32768
    s_cmp_eq_u32 s53, 3
    s_cbranch_scc1 L_dskip
    buffer_load_dwordx4 v105, s[32:35], s63 offen lds
L_dskip:
    s_waitcnt vmcnt(0)
    ds_read_b64_tr_b16 v[128:129], v6 offset:0
    ds_read_b64_tr_b16 v[130:131], v6 offset:64
    ds_read_b64_tr_b16 v[132:133], v6 offset:1024
    ds_read_b64_tr_b16 v[134:135], v6 offset:1088
    ds_read_b64_tr_b16 v[136:137], v6 offset:2048
    ds_read_b64_tr_b16 v[138:139], v6 offset:2112
    ds_read_b64_tr_b16 v[140:141], v6 offset:3072
    ds_read_b64_tr_b16 v[142:143], v6 offset:3136
    ds_read_b64_tr_b16 v[144:145], v6 offset:4096
    ds_read_b64_tr_b16 v[146:147], v6 offset:4160
    ds_read_b64_tr_b16 v[148:149], v6 offset:5120
    ds_read_b64_tr_b16 v[150:151], v6 offset:5184
    ds_read_b64_tr_b16 v[152:153], v6 offset:6144
    ds_read_b64_tr_b16 v[154:155], v6 offset:6208
    ds_read_b64_tr_b16 v[156:157], v6 offset:7168
    ds_read_b64_tr_b16 v[158:159], v6 offset:7232
    ds_read_b64_tr_b16 v[160:161], v6 offset:8192
    ds_read_b64_tr_b16 v[162:163], v6 offset:8256
    ds_read_b64_tr_b16 v[164:165], v6 offset:9216
    ds_read_b64_tr_b16 v[166:167], v6 offset:9280
    ds_read_b64_tr_b16 v[168:169], v6 offset:10240
    ds_read_b64_tr_b16 v[170:171], v6 offset:10304
    v_lshlrev_b32 v106, 16, v10
    v_and_b32 v107, 0xffff0000, v10
    v_lshlrev_b32 v10, 16, v11
    v_and_b32 v11, 0xffff0000, v11
    v_add_f32 v106, v106, v10
    v_add_f32 v107, v107, v11
    s_nop 0
    v_add_f32_dpp v106, v106, v106 row_ror:8 row_mask:0xf bank_mask:0xf
    v_add_f32_dpp v107, v107, v107 row_ror:8 row_mask:0xf bank_mask:0xf
    v_mov_b32 v10, v106
    v_mov_b32 v11, v107
    s_nop 1
    v_permlane16_swap_b32 v10, v106
    v_permlane16_swap_b32 v11, v107
    v_add_f32 v106, v106, v10
    v_add_f32 v107, v107, v11
    v_mov_b32 v10, v106
    v_mov_b32 v11, v107
    s_nop 1
    v_permlane32_swap_b32 v10, v106
    v_permlane32_swap_b32 v11, v107
    v_add_f32 v106, v106, v10
    v_add_f32 v107, v107, v11
    v_lshlrev_b32 v10, 16, v8
    v_and_b32 v11, 0xffff0000, v8
    v_add_f32 v106, v106, v10
    v_add_f32 v107, v107, v11
    v_cvt_pk_bf16_f32 v106, v106, v106
    v_and_b32 v106, 0xffff0000, v106
    v_cvt_pk_bf16_f32 v107, v107, v107
    v_and_b32 v107, 0xffff0000, v107
    s_waitcnt lgkmcnt(0)
    s_cmp_lg_u32 s53, 3
    s_cbranch_scc1 L_dnz
    v_mov_b32 v168, 0
    v_mov_b32 v169, 0
    v_mov_b32 v170, 0
    v_mov_b32 v171, 0
L_dnz:
    s_mov_b32 s62, 0
    s_branch L_dpoll_go
L_dpoll:
    s_add_u32 s62, s62, 1
    s_cmp_gt_u32 s62, 1000000
    s_cbranch_scc1 L_dpoll_ok
L_dpoll_go:
    s_mov_b64 exec, s[88:89]
    buffer_load_dwordx4 v[12:15], v5, s[44:47], 0 offen sc1
    buffer_load_dwordx4 v[20:23], v5, s[44:47], 0 offen offset:128 sc1
    s_mov_b64 exec, -1
    s_waitcnt vmcnt(0)
    v_max3_u32 v7, v12, v13, v14
    v_max3_u32 v7, v7, v15, v20
    v_max3_u32 v7, v7, v21, v22
    v_max_u32 v7, v7, v23
    v_cmp_eq_u32 vcc, -1, v7
    s_cbranch_vccnz L_dpoll
L_dpoll_ok:
    s_mov_b32 exec_hi, 0xfff
    v_lshlrev_b32 v8, 16, v12
    v_and_b32 v9, 0xffff0000, v12
    v_lshlrev_b32 v10, 16, v20
    v_and_b32 v11, 0xffff0000, v20
    v_pk_mul_f32 v[8:9], v[8:9], v[10:11]
    v_cvt_pk_bf16_f32 v12, v8, v9
    v_lshlrev_b32 v8, 16, v13
    v_and_b32 v9, 0xffff0000, v13
    v_lshlrev_b32 v10, 16, v21
    v_and_b32 v11, 0xffff0000, v21
    v_pk_mul_f32 v[8:9], v[8:9], v[10:11]
    v_cvt_pk_bf16_f32 v13, v8, v9
    v_lshlrev_b32 v8, 16, v14
    v_and_b32 v9, 0xffff0000, v14
    v_lshlrev_b32 v10, 16, v22
    v_and_b32 v11, 0xffff0000, v22
    v_pk_mul_f32 v[8:9], v[8:9], v[10:11]
    v_cvt_pk_bf16_f32 v14, v8, v9
    v_lshlrev_b32 v8, 16, v15
    v_and_b32 v9, 0xffff0000, v15
    v_lshlrev_b32 v10, 16, v23
    v_and_b32 v11, 0xffff0000, v23
    v_pk_mul_f32 v[8:9], v[8:9], v[10:11]
    v_cvt_pk_bf16_f32 v15, v8, v9
    ds_write_b128 v28, v[12:15]
    s_mov_b64 exec, -1
    ds_read_b128 v[32:35], v29 offset:6912
    ds_read_b128 v[36:39], v29 offset:7040
    ds_read_b128 v[40:43], v29 offset:7168
    ds_read_b128 v[44:47], v29 offset:7296
    ds_read_b128 v[48:51], v29 offset:7424
    ds_read_b128 v[52:55], v29 offset:7552
    s_waitcnt lgkmcnt(5)
    v_smfmac_f32_16x16x64_bf16 v[16:19], v[32:35], v[128:135], v104
    s_waitcnt lgkmcnt(4)
    v_smfmac_f32_16x16x64_bf16 v[16:19], v[36:39], v[136:143], v104
    s_waitcnt lgkmcnt(3)
    v_smfmac_f32_16x16x64_bf16 v[16:19], v[40:43], v[144:151], v104
    s_waitcnt lgkmcnt(2)
    v_smfmac_f32_16x16x64_bf16 v[16:19], v[44:47], v[152:159], v104
    s_waitcnt lgkmcnt(1)
    v_smfmac_f32_16x16x64_bf16 v[16:19], v[48:51], v[160:167], v104
    s_waitcnt lgkmcnt(0)
    v_smfmac_f32_16x16x64_bf16 v[16:19], v[52:55], v[168:175], v104
    s_mov_b64 exec, 0xffff
    s_cmp_lg_u32 s3, 0
    s_nop 5
    v_add_f32 v16, v16, v17
    ds_write_b32 v30, v16 offset:4608
    s_mov_b64 exec, 0xff
    s_waitcnt lgkmcnt(0)
    s_barrier
    s_cbranch_scc1 L_fin
    ds_read_b128 v[16:19], v31 offset:4608
    ds_read_b128 v[20:23], v31 offset:4624
    s_waitcnt lgkmcnt(0)
    v_pk_add_f32 v[16:17], v[16:17], v[18:19]
    v_pk_add_f32 v[20:21], v[20:21], v[22:23]
    v_add_f32 v10, v106, v16
    v_add_f32 v11, v107, v20
    v_add_f32 v10, v10, v17
    v_add_f32 v11, v11, v21
    v_cvt_pk_bf16_f32 v16, v10, v11
    buffer_store_dword v16, v27, s[36:39], s58 offen sc1
    s_branch L_fin
L_vwave:
    s_setprio 3
    s_lshl_b32 s63, s51, 3
    s_add_u32 s63, s63, s3
    s_mov_b32 s98, s50
    v_lshrrev_b32 v3, 4, v0
    v_and_b32 v4, 15, v0
    v_mov_b32 v24, 0
    v_mov_b32 v25, 1
    v_lshlrev_b32 v26, 3, v0
    v_lshlrev_b32 v27, 2, v0
    v_lshlrev_b32 v5, 5, v3
    v_lshlrev_b32 v6, 17, v3
    v_lshl_add_u32 v6, v4, 4, v6
    s_lshl_b32 s60, s51, 4
    s_add_u32 s60, s60, s53
    s_lshl_b32 s61, s60, 3
    s_lshl_b32 s60, s60, 15
    s_lshl_b32 s57, s50, 8
    s_add_u32 s60, s60, s57
    s_waitcnt lgkmcnt(0)
    s_mov_b64 s[16:17], s[64:65]
    s_mov_b32 s18, 1024
    s_mov_b32 s19, 0x20000
    s_mov_b64 s[12:13], s[70:71]
    s_mov_b32 s14, 4194304
    s_mov_b32 s15, 0x20000
    buffer_load_dwordx4 v[12:15], v2, s[16:19], 0 offen
    buffer_load_dwordx2 v[28:29], v5, s[16:19], s61 offen
    buffer_load_dwordx4 v[128:131], v6, s[12:15], s60 offen nt
    s_add_u32 s60, s60, 8192
    buffer_load_dwordx4 v[132:135], v6, s[12:15], s60 offen nt
    s_add_u32 s60, s60, 8192
    buffer_load_dwordx4 v[136:139], v6, s[12:15], s60 offen nt
    s_add_u32 s60, s60, 8192
    buffer_load_dwordx4 v[140:143], v6, s[12:15], s60 offen nt
    v_mov_b32 v8, 0
    v_mov_b32 v9, 0
    v_mov_b32 v10, 0
    v_mov_b32 v11, 0
    ds_write_b128 v8, v[8:11] offset:2064
    s_mov_b64 s[44:45], s[86:87]
    s_mov_b32 s46, 268435456
    s_mov_b32 s47, 0x20000
    s_mov_b64 s[40:41], s[84:85]
    s_mov_b32 s42, 256
    s_mov_b32 s43, 0x20000
    s_mov_b64 s[8:9], s[68:69]
    s_mov_b32 s10, 33554432
    s_mov_b32 s11, 0x20000
    s_lshl_b32 s55, s52, 9
    s_lshl_b32 s56, s52, 8
    s_add_u32 s56, s56, 196608
    s_waitcnt lgkmcnt(0)
    s_barrier
    s_load_dword s97, s[44:45], 294912
    s_cmp_lg_u32 s63, 6
    s_cbranch_scc1 L_noclr
    v_mov_b32 v8, -1
    v_mov_b32 v9, -1
    v_mov_b32 v10, -1
    v_mov_b32 v11, -1
    s_lshl_b32 s57, s98, 11
    s_add_u32 s57, s57, 196608
    buffer_store_dwordx4 v[8:11], v2, s[44:47], s57 offen sc1
    buffer_store_dwordx4 v[8:11], v2, s[44:47], s57 offen offset:1024 sc1
    s_lshl_b32 s57, s98, 9
    s_add_u32 s57, s57, 262144
    buffer_store_dwordx2 v[8:9], v26, s[44:47], s57 offen sc1
    s_mul_i32 s57, s98, 384
    s_add_u32 s57, s57, 278528
    s_mov_b32 exec_hi, 0xffff
    buffer_store_dwordx2 v[8:9], v26, s[44:47], s57 offen sc1
    s_lshl_b32 s57, s98, 10
    s_add_u32 s57, s57, 131072
    v_lshlrev_b32 v5, 7, v0
    s_mov_b64 exec, 0xff
    buffer_store_dwordx2 v[8:9], v5, s[44:47], s57 offen sc1
    s_mov_b64 exec, -1
L_noclr:
    v_and_b32 v5, 1, v4
    v_mov_b32 v6, 0xffff
    v_lshlrev_b32 v5, 4, v5
    v_lshlrev_b32 v6, v5, v6
    v_lshrrev_b32 v5, 1, v4
    v_cmp_eq_u32 vcc, 0, v5
    s_nop 1
    v_cndmask_b32 v20, 0, v6, vcc
    v_cmp_eq_u32 vcc, 1, v5
    s_nop 1
    v_cndmask_b32 v21, 0, v6, vcc
    v_cmp_eq_u32 vcc, 2, v5
    s_nop 1
    v_cndmask_b32 v22, 0, v6, vcc
    v_cmp_eq_u32 vcc, 3, v5
    s_nop 1
    v_cndmask_b32 v23, 0, v6, vcc
    s_waitcnt vmcnt(9)
    s_cmp_eq_u32 s63, 6
    s_cbranch_scc1 L_xw
    s_waitcnt vmcnt(4)
L_xw:
    v_lshlrev_b32 v32, 16, v12
    v_and_b32 v33, 0xffff0000, v12
    v_lshlrev_b32 v34, 16, v13
    v_and_b32 v35, 0xffff0000, v13
    v_lshlrev_b32 v36, 16, v14
    v_and_b32 v37, 0xffff0000, v14
    v_lshlrev_b32 v38, 16, v15
    v_and_b32 v39, 0xffff0000, v15
    v_add_f32 v8, v32, v33
    v_add_f32 v9, v34, v35
    v_add_f32 v10, v36, v37
    v_add_f32 v11, v38, v39
    v_add_f32 v8, v8, v9
    v_add_f32 v10, v10, v11
    v_add_f32 v8, v8, v10
    s_nop 1
    v_add_f32_dpp v8, v8, v8 row_ror:8 row_mask:0xf bank_mask:0xf
    s_nop 1
    v_add_f32_dpp v8, v8, v8 row_ror:4 row_mask:0xf bank_mask:0xf
    s_nop 1
    v_add_f32_dpp v8, v8, v8 row_ror:2 row_mask:0xf bank_mask:0xf
    s_nop 1
    v_add_f32_dpp v8, v8, v8 row_ror:1 row_mask:0xf bank_mask:0xf
    s_nop 1
    v_add_f32_dpp v8, v8, v8 row_bcast:15 row_mask:0xa bank_mask:0xf
    s_nop 1
    v_add_f32_dpp v8, v8, v8 row_bcast:31 row_mask:0xc bank_mask:0xf
    s_nop 0
    v_readlane_b32 s60, v8, 63
    s_nop 1
    v_mov_b32 v8, s60
    v_mul_f32 v8, 0x3b000000, v8
    v_sub_f32 v32, v32, v8
    v_sub_f32 v33, v33, v8
    v_sub_f32 v34, v34, v8
    v_sub_f32 v35, v35, v8
    v_sub_f32 v36, v36, v8
    v_sub_f32 v37, v37, v8
    v_sub_f32 v38, v38, v8
    v_sub_f32 v39, v39, v8
    v_mul_f32 v9, v32, v32
    v_fmac_f32 v9, v33, v33
    v_fmac_f32 v9, v34, v34
    v_fmac_f32 v9, v35, v35
    v_fmac_f32 v9, v36, v36
    v_fmac_f32 v9, v37, v37
    v_fmac_f32 v9, v38, v38
    v_fmac_f32 v9, v39, v39
    s_nop 1
    v_add_f32_dpp v9, v9, v9 row_ror:8 row_mask:0xf bank_mask:0xf
    s_nop 1
    v_add_f32_dpp v9, v9, v9 row_ror:4 row_mask:0xf bank_mask:0xf
    s_nop 1
    v_add_f32_dpp v9, v9, v9 row_ror:2 row_mask:0xf bank_mask:0xf
    s_nop 1
    v_add_f32_dpp v9, v9, v9 row_ror:1 row_mask:0xf bank_mask:0xf
    s_nop 1
    v_add_f32_dpp v9, v9, v9 row_bcast:15 row_mask:0xa bank_mask:0xf
    s_nop 1
    v_add_f32_dpp v9, v9, v9 row_bcast:31 row_mask:0xc bank_mask:0xf
    s_nop 0
    v_readlane_b32 s61, v9, 63
    s_nop 1
    v_mov_b32 v9, s61
    v_mul_f32 v9, 0x3b000000, v9
    v_cvt_pk_bf16_f32 v8, v8, v8
    v_and_b32 v8, 0xffff0000, v8
    v_cvt_pk_bf16_f32 v9, v9, v9
    v_and_b32 v9, 0xffff0000, v9
    v_add_f32 v9, 0x3727c5ac, v9
    v_cvt_pk_bf16_f32 v9, v9, v9
    v_and_b32 v9, 0xffff0000, v9
    v_sqrt_f32 v9, v9
    s_nop 0
    v_cvt_pk_bf16_f32 v9, v9, v9
    v_and_b32 v9, 0xffff0000, v9
    v_rcp_f32 v9, v9
    v_lshlrev_b32 v32, 16, v28
    v_and_b32 v33, 0xffff0000, v28
    v_lshlrev_b32 v34, 16, v29
    v_and_b32 v35, 0xffff0000, v29
    v_sub_f32 v32, v32, v8
    v_sub_f32 v33, v33, v8
    v_sub_f32 v34, v34, v8
    v_sub_f32 v35, v35, v8
    v_cvt_pk_bf16_f32 v32, v32, v32
    v_and_b32 v32, 0xffff0000, v32
    v_cvt_pk_bf16_f32 v33, v33, v33
    v_and_b32 v33, 0xffff0000, v33
    v_cvt_pk_bf16_f32 v34, v34, v34
    v_and_b32 v34, 0xffff0000, v34
    v_cvt_pk_bf16_f32 v35, v35, v35
    v_and_b32 v35, 0xffff0000, v35
    v_mul_f32 v32, v32, v9
    v_mul_f32 v33, v33, v9
    v_mul_f32 v34, v34, v9
    v_mul_f32 v35, v35, v9
    v_cvt_pk_bf16_f32 v32, v32, v32
    v_cvt_pk_bf16_f32 v33, v33, v33
    v_cvt_pk_bf16_f32 v34, v34, v34
    v_cvt_pk_bf16_f32 v35, v35, v35
    s_waitcnt vmcnt(5)
    s_cmp_eq_u32 s63, 6
    s_cbranch_scc1 L_qw
    s_waitcnt vmcnt(0)
L_qw:
    v_and_b32 v8, v32, v20
    v_and_b32 v9, v32, v21
    v_and_b32 v10, v32, v22
    v_and_b32 v11, v32, v23
    v_and_b32 v12, v33, v20
    v_and_b32 v13, v33, v21
    v_and_b32 v14, v33, v22
    v_and_b32 v15, v33, v23
    v_mfma_f32_16x16x32_bf16 v[16:19], v[8:11], v[128:131], 0
    v_and_b32 v8, v34, v20
    v_and_b32 v9, v34, v21
    v_and_b32 v10, v34, v22
    v_and_b32 v11, v34, v23
    v_mfma_f32_16x16x32_bf16 v[16:19], v[12:15], v[132:135], v[16:19]
    v_and_b32 v12, v35, v20
    v_and_b32 v13, v35, v21
    v_and_b32 v14, v35, v22
    v_and_b32 v15, v35, v23
    v_mfma_f32_16x16x32_bf16 v[16:19], v[8:11], v[136:139], v[16:19]
    s_cmp_lg_u32 s3, 4
    s_nop 0
    v_mfma_f32_16x16x32_bf16 v[16:19], v[12:15], v[140:143], v[16:19]
    v_lshlrev_b32 v5, 5, v4
    v_lshl_add_u32 v5, v3, 4, v5
    s_lshl_b32 s57, s53, 9
    v_add_u32 v5, s57, v5
    s_mov_b32 exec_hi, 0
    s_nop 3
    ds_write_b128 v5, v[16:19] offset:2560
    s_mov_b64 exec, 1
    ds_add_rtn_u32 v7, v24, v25 offset:2064
    s_waitcnt lgkmcnt(0)
    v_readfirstlane_b32 s57, v7
    s_mov_b64 exec, -1
    s_nop 2
    s_cmp_lt_u32 s57, 3
    s_cbranch_scc1 L_qnotlast
    ds_read_b64 v[8:9], v26 offset:2560
    ds_read_b64 v[10:11], v26 offset:3072
    ds_read_b64 v[12:13], v26 offset:3584
    ds_read_b64 v[14:15], v26 offset:4096
    s_add_u32 s57, s97, 1
    s_waitcnt lgkmcnt(2)
    v_pk_add_f32 v[8:9], v[8:9], v[10:11]
    s_waitcnt lgkmcnt(0)
    v_pk_add_f32 v[12:13], v[12:13], v[14:15]
    v_pk_add_f32 v[8:9], v[8:9], v[12:13]
    v_cvt_pk_bf16_f32 v8, v8, v9
    v_mov_b32 v9, s57
    buffer_store_dwordx2 v[8:9], v26, s[44:47], s55 offen offset:0 sc1
    s_waitcnt vmcnt(1)
    s_branch L_qdone
L_qnotlast:
    s_waitcnt vmcnt(0)
L_qdone:
    s_cmp_lg_u32 s63, 6
    s_cbranch_scc1 L_nocount
    s_mov_b64 exec, 1
    buffer_atomic_add v25, v24, s[40:43], 0 offen sc1
    s_mov_b64 exec, -1
L_nocount:
    s_setprio 0
    s_barrier
    buffer_load_dwordx4 v[128:131], v2, s[8:11], s54 offen nt
    s_add_u32 s54, s54, 4096
    buffer_load_dwordx4 v[132:135], v2, s[8:11], s54 offen nt
    s_add_u32 s54, s54, 4096
    buffer_load_dwordx4 v[136:139], v2, s[8:11], s54 offen nt
    s_add_u32 s54, s54, 4096
    buffer_load_dwordx4 v[140:143], v2, s[8:11], s54 offen nt
    s_add_u32 s54, s54, 4096
    buffer_load_dwordx4 v[144:147], v2, s[8:11], s54 offen nt
    s_add_u32 s54, s54, 4096
    buffer_load_dwordx4 v[148:151], v2, s[8:11], s54 offen nt
    s_add_u32 s54, s54, 4096
    buffer_load_dwordx4 v[152:155], v2, s[8:11], s54 offen nt
    s_add_u32 s54, s54, 4096
    buffer_load_dwordx4 v[156:159], v2, s[8:11], s54 offen nt
    s_add_u32 s54, s54, 4096
    buffer_load_dwordx4 v[160:163], v2, s[8:11], s54 offen nt
    s_add_u32 s54, s54, 4096
    buffer_load_dwordx4 v[164:167], v2, s[8:11], s54 offen nt
    s_add_u32 s54, s54, 4096
    s_waitcnt vmcnt(9)
    buffer_load_dwordx4 v[168:171], v2, s[8:11], s54 offen nt
    s_add_u32 s54, s54, 4096
    s_waitcnt vmcnt(9)
    buffer_load_dwordx4 v[172:175], v2, s[8:11], s54 offen nt
    s_add_u32 s54, s54, 4096
    s_waitcnt vmcnt(9)
    buffer_load_dwordx4 v[176:179], v2, s[8:11], s54 offen nt
    s_add_u32 s54, s54, 4096
    s_waitcnt vmcnt(9)
    buffer_load_dwordx4 v[180:183], v2, s[8:11], s54 offen nt
    s_add_u32 s54, s54, 4096
    s_waitcnt vmcnt(9)
    buffer_load_dwordx4 v[184:187], v2, s[8:11], s54 offen nt
    s_add_u32 s54, s54, 4096
    s_waitcnt vmcnt(9)
    buffer_load_dwordx4 v[188:191], v2, s[8:11], s54 offen nt
    s_add_u32 s54, s54, 4096
    s_waitcnt vmcnt(9)
    buffer_load_dwordx4 v[192:195], v2, s[8:11], s54 offen nt
    s_add_u32 s54, s54, 4096
    s_waitcnt vmcnt(9)
    buffer_load_dwordx4 v[196:199], v2, s[8:11], s54 offen nt
    s_add_u32 s54, s54, 4096
    s_waitcnt vmcnt(9)
    buffer_load_dwordx4 v[200:203], v2, s[8:11], s54 offen nt
    s_add_u32 s54, s54, 4096
    s_waitcnt vmcnt(9)
    buffer_load_dwordx4 v[204:207], v2, s[8:11], s54 offen nt
    s_add_u32 s54, s54, 4096
    s_waitcnt vmcnt(9)
    buffer_load_dwordx4 v[208:211], v2, s[8:11], s54 offen nt
    s_add_u32 s54, s54, 4096
    s_waitcnt vmcnt(9)
    buffer_load_dwordx4 v[212:215], v2, s[8:11], s54 offen nt
    s_add_u32 s54, s54, 4096
    s_waitcnt vmcnt(9)
    buffer_load_dwordx4 v[216:219], v2, s[8:11], s54 offen nt
    s_add_u32 s54, s54, 4096
    s_waitcnt vmcnt(9)
    buffer_load_dwordx4 v[220:223], v2, s[8:11], s54 offen nt
    s_add_u32 s54, s54, 4096
    s_waitcnt vmcnt(9)
    buffer_load_dwordx4 v[224:227], v2, s[8:11], s54 offen nt
    s_add_u32 s54, s54, 4096
    s_waitcnt vmcnt(9)
    buffer_load_dwordx4 v[228:231], v2, s[8:11], s54 offen nt
    s_add_u32 s54, s54, 4096
    s_waitcnt vmcnt(9)
    buffer_load_dwordx4 v[232:235], v2, s[8:11], s54 offen nt
    s_add_u32 s54, s54, 4096
    s_waitcnt vmcnt(9)
    buffer_load_dwordx4 v[236:239], v2, s[8:11], s54 offen nt
    s_add_u32 s54, s54, 4096
    s_waitcnt vmcnt(9)
    buffer_load_dwordx4 v[240:243], v2, s[8:11], s54 offen nt
    s_add_u32 s54, s54, 4096
    s_waitcnt vmcnt(9)
    buffer_load_dwordx4 v[244:247], v2, s[8:11], s54 offen nt
    s_add_u32 s54, s54, 4096
    s_waitcnt vmcnt(9)
    buffer_load_dwordx4 v[248:251], v2, s[8:11], s54 offen nt
    s_add_u32 s54, s54, 4096
    s_waitcnt vmcnt(9)
    buffer_load_dwordx4 v[252:255], v2, s[8:11], s54 offen nt
    s_setprio 2
    s_lshl_b32 s55, s53, 9
    v_lshlrev_b32 v6, 7, v3
    v_add_u32 v6, s55, v6
    s_lshl_b32 s55, s53, 2
    v_mov_b32 v7, s55
    s_lshl_b32 s55, s52, 7
    s_add_u32 s55, s55, 131072
    s_barrier
    ds_read_b128 v[32:35], v6 offset:0
    ds_read_b128 v[36:39], v6 offset:16
    ds_read_b128 v[40:43], v6 offset:32
    ds_read_b128 v[44:47], v6 offset:48
    ds_read_b128 v[48:51], v6 offset:64
    ds_read_b128 v[52:55], v6 offset:80
    ds_read_b128 v[56:59], v6 offset:96
    ds_read_b128 v[60:63], v6 offset:112
    ds_read_b32 v28, v7 offset:2048
    s_waitcnt lgkmcnt(0)
    v_and_b32 v8, v32, v20
    v_and_b32 v9, v32, v21
    v_and_b32 v10, v32, v22
    v_and_b32 v11, v32, v23
    v_and_b32 v12, v33, v20
    v_and_b32 v13, v33, v21
    v_and_b32 v14, v33, v22
    v_and_b32 v15, v33, v23
    s_waitcnt vmcnt(31)
    v_mfma_f32_16x16x32_bf16 v[16:19], v[8:11], v[128:131], 0
    v_and_b32 v8, v34, v20
    v_and_b32 v9, v34, v21
    v_and_b32 v10, v34, v22
    v_and_b32 v11, v34, v23
    s_waitcnt vmcnt(30)
    v_mfma_f32_16x16x32_bf16 v[16:19], v[12:15], v[132:135], v[16:19]
    v_and_b32 v12, v35, v20
    v_and_b32 v13, v35, v21
    v_and_b32 v14, v35, v22
    v_and_b32 v15, v35, v23
    s_waitcnt vmcnt(29)
    v_mfma_f32_16x16x32_bf16 v[16:19], v[8:11], v[136:139], v[16:19]
    v_and_b32 v8, v36, v20
    v_and_b32 v9, v36, v21
    v_and_b32 v10, v36, v22
    v_and_b32 v11, v36, v23
    s_waitcnt vmcnt(28)
    v_mfma_f32_16x16x32_bf16 v[16:19], v[12:15], v[140:143], v[16:19]
    v_and_b32 v12, v37, v20
    v_and_b32 v13, v37, v21
    v_and_b32 v14, v37, v22
    v_and_b32 v15, v37, v23
    s_waitcnt vmcnt(27)
    v_mfma_f32_16x16x32_bf16 v[16:19], v[8:11], v[144:147], v[16:19]
    v_and_b32 v8, v38, v20
    v_and_b32 v9, v38, v21
    v_and_b32 v10, v38, v22
    v_and_b32 v11, v38, v23
    s_waitcnt vmcnt(26)
    v_mfma_f32_16x16x32_bf16 v[16:19], v[12:15], v[148:151], v[16:19]
    v_and_b32 v12, v39, v20
    v_and_b32 v13, v39, v21
    v_and_b32 v14, v39, v22
    v_and_b32 v15, v39, v23
    s_waitcnt vmcnt(25)
    v_mfma_f32_16x16x32_bf16 v[16:19], v[8:11], v[152:155], v[16:19]
    v_and_b32 v8, v40, v20
    v_and_b32 v9, v40, v21
    v_and_b32 v10, v40, v22
    v_and_b32 v11, v40, v23
    s_waitcnt vmcnt(24)
    v_mfma_f32_16x16x32_bf16 v[16:19], v[12:15], v[156:159], v[16:19]
    v_and_b32 v12, v41, v20
    v_and_b32 v13, v41, v21
    v_and_b32 v14, v41, v22
    v_and_b32 v15, v41, v23
    s_waitcnt vmcnt(23)
    v_mfma_f32_16x16x32_bf16 v[16:19], v[8:11], v[160:163], v[16:19]
    v_and_b32 v8, v42, v20
    v_and_b32 v9, v42, v21
    v_and_b32 v10, v42, v22
    v_and_b32 v11, v42, v23
    s_waitcnt vmcnt(22)
    v_mfma_f32_16x16x32_bf16 v[16:19], v[12:15], v[164:167], v[16:19]
    v_and_b32 v12, v43, v20
    v_and_b32 v13, v43, v21
    v_and_b32 v14, v43, v22
    v_and_b32 v15, v43, v23
    s_waitcnt vmcnt(21)
    v_mfma_f32_16x16x32_bf16 v[16:19], v[8:11], v[168:171], v[16:19]
    v_and_b32 v8, v44, v20
    v_and_b32 v9, v44, v21
    v_and_b32 v10, v44, v22
    v_and_b32 v11, v44, v23
    s_waitcnt vmcnt(20)
    v_mfma_f32_16x16x32_bf16 v[16:19], v[12:15], v[172:175], v[16:19]
    v_and_b32 v12, v45, v20
    v_and_b32 v13, v45, v21
    v_and_b32 v14, v45, v22
    v_and_b32 v15, v45, v23
    s_waitcnt vmcnt(19)
    v_mfma_f32_16x16x32_bf16 v[16:19], v[8:11], v[176:179], v[16:19]
    v_and_b32 v8, v46, v20
    v_and_b32 v9, v46, v21
    v_and_b32 v10, v46, v22
    v_and_b32 v11, v46, v23
    s_waitcnt vmcnt(18)
    v_mfma_f32_16x16x32_bf16 v[16:19], v[12:15], v[180:183], v[16:19]
    v_and_b32 v12, v47, v20
    v_and_b32 v13, v47, v21
    v_and_b32 v14, v47, v22
    v_and_b32 v15, v47, v23
    s_waitcnt vmcnt(17)
    v_mfma_f32_16x16x32_bf16 v[16:19], v[8:11], v[184:187], v[16:19]
    v_and_b32 v8, v48, v20
    v_and_b32 v9, v48, v21
    v_and_b32 v10, v48, v22
    v_and_b32 v11, v48, v23
    s_waitcnt vmcnt(16)
    v_mfma_f32_16x16x32_bf16 v[16:19], v[12:15], v[188:191], v[16:19]
    v_and_b32 v12, v49, v20
    v_and_b32 v13, v49, v21
    v_and_b32 v14, v49, v22
    v_and_b32 v15, v49, v23
    s_waitcnt vmcnt(15)
    v_mfma_f32_16x16x32_bf16 v[16:19], v[8:11], v[192:195], v[16:19]
    v_and_b32 v8, v50, v20
    v_and_b32 v9, v50, v21
    v_and_b32 v10, v50, v22
    v_and_b32 v11, v50, v23
    s_waitcnt vmcnt(14)
    v_mfma_f32_16x16x32_bf16 v[16:19], v[12:15], v[196:199], v[16:19]
    v_and_b32 v12, v51, v20
    v_and_b32 v13, v51, v21
    v_and_b32 v14, v51, v22
    v_and_b32 v15, v51, v23
    s_waitcnt vmcnt(13)
    v_mfma_f32_16x16x32_bf16 v[16:19], v[8:11], v[200:203], v[16:19]
    v_and_b32 v8, v52, v20
    v_and_b32 v9, v52, v21
    v_and_b32 v10, v52, v22
    v_and_b32 v11, v52, v23
    s_waitcnt vmcnt(12)
    v_mfma_f32_16x16x32_bf16 v[16:19], v[12:15], v[204:207], v[16:19]
    v_and_b32 v12, v53, v20
    v_and_b32 v13, v53, v21
    v_and_b32 v14, v53, v22
    v_and_b32 v15, v53, v23
    s_waitcnt vmcnt(11)
    v_mfma_f32_16x16x32_bf16 v[16:19], v[8:11], v[208:211], v[16:19]
    v_and_b32 v8, v54, v20
    v_and_b32 v9, v54, v21
    v_and_b32 v10, v54, v22
    v_and_b32 v11, v54, v23
    s_waitcnt vmcnt(10)
    v_mfma_f32_16x16x32_bf16 v[16:19], v[12:15], v[212:215], v[16:19]
    v_and_b32 v12, v55, v20
    v_and_b32 v13, v55, v21
    v_and_b32 v14, v55, v22
    v_and_b32 v15, v55, v23
    s_waitcnt vmcnt(9)
    v_mfma_f32_16x16x32_bf16 v[16:19], v[8:11], v[216:219], v[16:19]
    v_and_b32 v8, v56, v20
    v_and_b32 v9, v56, v21
    v_and_b32 v10, v56, v22
    v_and_b32 v11, v56, v23
    s_waitcnt vmcnt(8)
    v_mfma_f32_16x16x32_bf16 v[16:19], v[12:15], v[220:223], v[16:19]
    v_and_b32 v12, v57, v20
    v_and_b32 v13, v57, v21
    v_and_b32 v14, v57, v22
    v_and_b32 v15, v57, v23
    s_waitcnt vmcnt(7)
    v_mfma_f32_16x16x32_bf16 v[16:19], v[8:11], v[224:227], v[16:19]
    v_and_b32 v8, v58, v20
    v_and_b32 v9, v58, v21
    v_and_b32 v10, v58, v22
    v_and_b32 v11, v58, v23
    s_waitcnt vmcnt(6)
    v_mfma_f32_16x16x32_bf16 v[16:19], v[12:15], v[228:231], v[16:19]
    s_barrier
    v_and_b32 v12, v59, v20
    v_and_b32 v13, v59, v21
    v_and_b32 v14, v59, v22
    v_and_b32 v15, v59, v23
    s_waitcnt vmcnt(5)
    v_mfma_f32_16x16x32_bf16 v[16:19], v[8:11], v[232:235], v[16:19]
    v_and_b32 v8, v60, v20
    v_and_b32 v9, v60, v21
    v_and_b32 v10, v60, v22
    v_and_b32 v11, v60, v23
    s_waitcnt vmcnt(4)
    v_mfma_f32_16x16x32_bf16 v[16:19], v[12:15], v[236:239], v[16:19]
    v_and_b32 v12, v61, v20
    v_and_b32 v13, v61, v21
    v_and_b32 v14, v61, v22
    v_and_b32 v15, v61, v23
    s_waitcnt vmcnt(3)
    v_mfma_f32_16x16x32_bf16 v[16:19], v[8:11], v[240:243], v[16:19]
    v_and_b32 v8, v62, v20
    v_and_b32 v9, v62, v21
    v_and_b32 v10, v62, v22
    v_and_b32 v11, v62, v23
    s_waitcnt vmcnt(2)
    v_mfma_f32_16x16x32_bf16 v[16:19], v[12:15], v[244:247], v[16:19]
    v_and_b32 v12, v63, v20
    v_and_b32 v13, v63, v21
    v_and_b32 v14, v63, v22
    v_and_b32 v15, v63, v23
    s_waitcnt vmcnt(1)
    v_mfma_f32_16x16x32_bf16 v[16:19], v[8:11], v[248:251], v[16:19]
    s_cmp_lg_u32 s3, 4
    s_nop 0
    s_waitcnt vmcnt(0)
    v_mfma_f32_16x16x32_bf16 v[16:19], v[12:15], v[252:255], v[16:19]
    s_mov_b32 exec_hi, 0
    s_nop 6
    v_pk_mul_f32 v[16:17], v[16:17], v[28:29] op_sel_hi:[1,0]
    v_pk_mul_f32 v[18:19], v[18:19], v[28:29] op_sel_hi:[1,0]
    ds_write_b128 v5, v[16:19] offset:2560
    s_mov_b64 exec, -1
    s_waitcnt lgkmcnt(0)
    s_barrier
    s_cbranch_scc1 L_fin
    ds_read_b64 v[8:9], v26 offset:2560
    ds_read_b64 v[10:11], v26 offset:3072
    ds_read_b64 v[12:13], v26 offset:3584
    ds_read_b64 v[14:15], v26 offset:4096
    s_waitcnt lgkmcnt(2)
    v_pk_add_f32 v[8:9], v[8:9], v[10:11]
    s_waitcnt lgkmcnt(0)
    v_pk_add_f32 v[12:13], v[12:13], v[14:15]
    v_pk_add_f32 v[8:9], v[8:9], v[12:13]
    v_cvt_pk_bf16_f32 v8, v8, v9
    v_min_u32 v8, -2, v8
    buffer_store_dword v8, v27, s[44:47], s56 offen sc1
    s_barrier
L_fin:
L_end:
    s_endpgm
.fill 512, 4, 0xbf800000
.section .rodata,"a"
.p2align 6
.amdhsa_kernel sequential_preLN__mha_block_cached__glu_gated_glu__decode_kernel
  .amdhsa_next_free_vgpr 256
  .amdhsa_next_free_sgpr 102
  .amdhsa_accum_offset 256
  .amdhsa_group_segment_fixed_size 0
  .amdhsa_kernarg_size 96
  .amdhsa_user_sgpr_count 2
  .amdhsa_user_sgpr_kernarg_segment_ptr 1
  .amdhsa_system_sgpr_workgroup_id_x 1
.end_amdhsa_kernel
```
